```python
import torch

def _softmax(x, axis=-1):
    return torch.softmax(x, dim=axis)
def _gelu(x):
    return torch.nn.functional.gelu(x, approximate="tanh")
def _silu(x):
    return torch.nn.functional.silu(x)
def _sigmoid(x):
    return torch.sigmoid(x)
def _layernorm(x, axis=-1, eps=1e-5):
    m = x.mean(dim=axis, keepdim=True)
    v = x.var(dim=axis, keepdim=True, unbiased=False)
    return (x - m) / torch.sqrt(v + eps)
def _scatter_add(tgt, idx, src, axis=0):
    return tgt.clone().index_add_(axis, idx, src)
def _segment_sum(src, seg, n):
    out = torch.zeros((n,) + src.shape[1:], dtype=src.dtype)
    return out.index_add_(0, seg, src)
def _pad(x, pw):
    flat = tuple(v for pair in reversed(pw) for v in pair)
    return torch.nn.functional.pad(x, flat)

kernel_name = 'parallel_sum__gqa_block_cached__glu_gated_swiglu__decode'

def setup_inputs():

    _w = (lambda a: (lambda t: t.to(torch.bfloat16) if t.is_floating_point() else t)(torch.as_tensor(a)))
    def _A_setup():
        B, Sq, D = 2, 1, 448
        Hq, Hkv, Sk, Dh = 16, 8, 32768, 256
        assert Hq % Hkv == 0, (Hq, Hkv)
        return {
            "x": _w((lambda *s: torch.randn(*s, dtype=torch.bfloat16) * 0.05)(B, Sq, D)),
            "k_cache": _w((lambda *s: torch.randn(*s, dtype=torch.bfloat16) * 3.2)(B, Hkv, Sk, Dh)),
            "v_cache": _w((lambda *s: torch.randn(*s, dtype=torch.bfloat16) * 1.6)(B, Hkv, Sk, Dh)),
            "wq": _w((lambda *s: torch.randn(*s, dtype=torch.bfloat16) * 3.2)(D, Hq * Dh) * (D ** -0.5)),
            "wo": _w((lambda *s: torch.randn(*s, dtype=torch.bfloat16) * 1.6)(Hq * Dh, D) * ((Hq * Dh) ** -0.5)),
        }
    _A_in = _A_setup()

    def _B_setup():
        B, S, D, F = 2, 1, 448, 1792
        return {
            "x": _w((lambda *s: torch.randn(*s, dtype=torch.bfloat16) * 0.05)(B, S, D)),
            "w1": _w((lambda *s: torch.randn(*s, dtype=torch.bfloat16) * 1.6)(D, F) * (2.0 / D) ** 0.5),
            "w3": _w((lambda *s: torch.randn(*s, dtype=torch.bfloat16) * 1.6)(D, F) * (2.0 / D) ** 0.5),
            "w2": _w((lambda *s: torch.randn(*s, dtype=torch.bfloat16) * 1.6)(F, D) * (2.0 / F) ** 0.5),
        }
    _B_in = _B_setup()

    return {
        "A_x": _A_in["x"],
        "A_k_cache": _A_in["k_cache"],
        "A_v_cache": _A_in["v_cache"],
        "A_wq": _A_in["wq"],
        "A_wo": _A_in["wo"],
        "B_x": _B_in["x"],
        "B_w1": _B_in["w1"],
        "B_w3": _B_in["w3"],
        "B_w2": _B_in["w2"],
    }

def reference(A_x, A_k_cache, A_v_cache, A_wq, A_wo, B_x, B_w1, B_w3, B_w2):
    def _A_ref(x, k_cache, v_cache, wq, wo):
        B, Sq, D = x.shape
        Hq, Dh = 16, 256
        Hkv = k_cache.shape[1]
        rep = Hq // Hkv
        q = (lambda x, *d: x.permute(*d))((x @ wq).reshape(B, Sq, Hq, Dh), 0, 2, 1, 3)
        k = (lambda x, n, axis: torch.repeat_interleave(x, n, dim=axis))(k_cache, rep, axis=1)
        v = (lambda x, n, axis: torch.repeat_interleave(x, n, dim=axis))(v_cache, rep, axis=1)
        scores = torch.einsum("bhqd,bhkd->bhqk", q, k) * (Dh ** -0.5)
        p = _softmax(scores, axis=-1)
        o = torch.einsum("bhqk,bhkd->bhqd", p, v)
        return (lambda x, *d: x.permute(*d))(o, 0, 2, 1, 3).reshape(B, Sq, Hq * Dh) @ wo

    def _B_ref(x, w1, w3, w2):
        gate = torch.einsum("bsd,df->bsf", x, w1)
        up = torch.einsum("bsd,df->bsf", x, w3)
        h = _silu(gate) * up
        out = torch.einsum("bsf,fd->bsd", h, w2)
        return out

    x = A_x
    xn = _layernorm(x, axis=-1)
    return x + _A_ref(xn, A_k_cache, A_v_cache, A_wq, A_wo) + _B_ref(xn, B_w1, B_w3, B_w2)
```

```asm
; @launch grid=(256,1,1) block=(256,1,1) lds=82944
.amdgcn_target "amdgcn-amd-amdhsa--gfx950"
.text
.globl parallel_sum__gqa_block_cached__glu_gated_swiglu__decode_kernel
.p2align 8
.type parallel_sum__gqa_block_cached__glu_gated_swiglu__decode_kernel,@function
parallel_sum__gqa_block_cached__glu_gated_swiglu__decode_kernel:
    s_cmp_ge_u32 s2, 256
    s_cbranch_scc1 L_ecode_kernel_end2
    s_load_dwordx16 s[16:31], s[0:1], 0
    s_load_dwordx8 s[32:39], s[0:1], 64
    v_lshrrev_b32 v1, 6, v0
    v_lshrrev_b32 v12, 3, v0
    v_and_b32 v0, 63, v0
    v_readfirstlane_b32 s3, v1
    s_and_b32 s4, s2, 15
    s_lshr_b32 s5, s2, 4
    v_and_b32 v11, 31, v0
    v_lshlrev_b32 v11, 2, v11
    v_lshrrev_b32 v8, 5, v0
    v_mul_u32_u24 v8, 896, v8
    v_add_u32 v11, v11, v8
    v_and_b32 v13, 7, v0
    v_lshlrev_b32 v5, 13, v12
    v_lshl_add_u32 v5, v13, 4, v5
    s_mov_b32 s62, 1792
    s_mov_b32 s63, 0x20000
    s_mov_b32 s54, 3670016
    s_mov_b32 s55, 0x20000
    s_lshr_b32 s12, s2, 6
    s_and_b32 s13, s2, 63
    s_mul_i32 s14, s12, 917504
    s_lshl_b32 s15, s13, 7
    s_add_u32 s14, s14, s15
    v_and_b32 v1, 3, v0
    v_lshlrev_b32 v1, 4, v1
    v_lshrrev_b32 v7, 4, v0
    v_lshl_add_u32 v1, v7, 6, v1
    v_bfe_u32 v15, v0, 3, 1
    v_lshl_add_u32 v15, v15, 9, v1
    v_bfe_u32 v8, v0, 2, 2
    v_lshl_add_u32 v1, v8, 9, v1
    v_add_u32 v2, 0x1000, v1
    s_lshl_b32 s6, s4, 24
    s_lshl_b32 s7, s5, 2
    s_add_u32 s7, s7, s3
    s_lshl_b32 s7, s7, 13
    s_add_u32 s6, s6, s7
    s_mov_b32 s99, s6
    s_mov_b32 s42, 0x10000000
    s_mov_b32 s43, 0x20000
    s_waitcnt lgkmcnt(0)
    s_mov_b32 s60, s16
    s_mov_b32 s61, s17
    s_mov_b32 s52, s22
    s_mov_b32 s53, s23
    buffer_load_dword v20, v11, s[60:63], 0 offen offset:0
    buffer_load_dword v21, v11, s[60:63], 0 offen offset:128
    buffer_load_dword v22, v11, s[60:63], 0 offen offset:256
    buffer_load_dword v23, v11, s[60:63], 0 offen offset:384
    buffer_load_dword v24, v11, s[60:63], 0 offen offset:512
    buffer_load_dword v25, v11, s[60:63], 0 offen offset:640
    buffer_load_dword v26, v11, s[60:63], 0 offen offset:768
    buffer_load_dwordx4 v[28:31], v5, s[52:55], s14 offen nt
    s_add_u32 s14, s14, 262144
    buffer_load_dwordx4 v[32:35], v5, s[52:55], s14 offen nt
    s_add_u32 s14, s14, 262144
    buffer_load_dwordx4 v[36:39], v5, s[52:55], s14 offen nt
    s_add_u32 s14, s14, 262144
    s_cmp_ge_u32 s3, 2
    s_cselect_b32 s14, 0x7fff0000, s14
    buffer_load_dwordx4 v[40:43], v5, s[52:55], s14 offen nt
    s_mov_b32 s40, s18
    s_mov_b32 s41, s19
    s_barrier
    s_and_b32 s100, s6, 4278583295
    s_and_b32 s101, s6, 131072
    s_lshl_b32 s101, s101, 4
    s_or_b32 s100, s100, s101
    s_and_b32 s101, s6, 524288
    s_lshr_b32 s101, s101, 2
    s_or_b32 s100, s100, s101
    s_and_b32 s101, s6, 1048576
    s_lshl_b32 s101, s101, 3
    s_or_b32 s100, s100, s101
    s_and_b32 s101, s6, 2097152
    s_lshl_b32 s101, s101, 1
    s_or_b32 s100, s100, s101
    s_and_b32 s101, s6, 12582912
    s_lshr_b32 s101, s101, 3
    s_or_b32 s100, s100, s101
    buffer_load_dwordx4 v[128:131], v1, s[40:43], s100 offen offset:0 nt
    buffer_load_dwordx4 v[132:135], v1, s[40:43], s100 offen offset:256 nt
    buffer_load_dwordx4 v[136:139], v1, s[40:43], s100 offen offset:2048 nt
    buffer_load_dwordx4 v[140:143], v1, s[40:43], s100 offen offset:2304 nt
    buffer_load_dwordx4 v[144:147], v2, s[40:43], s100 offen offset:0 nt
    buffer_load_dwordx4 v[148:151], v2, s[40:43], s100 offen offset:256 nt
    buffer_load_dwordx4 v[152:155], v2, s[40:43], s100 offen offset:2048 nt
    buffer_load_dwordx4 v[156:159], v2, s[40:43], s100 offen offset:2304 nt
    s_add_u32 s6, s6, 0x80000
    s_add_u32 s76, s38, 2479104
    s_addc_u32 s77, s39, 0
    s_load_dword s97, s[76:77], 0
    v_and_b32 v10, 15, v0
    v_lshlrev_b32 v10, 4, v10
    v_lshl_add_u32 v3, v7, 9, v10
    v_add_u32 v4, 0x1000, v3
    v_mul_u32_u24 v9, 3584, v12
    v_lshl_add_u32 v9, v13, 4, v9
    s_mov_b32 s58, 1605632
    s_mov_b32 s59, 0x20000
    s_and_b32 s71, s2, 3
    s_lshr_b32 s72, s2, 3
    s_mul_i32 s15, s71, 401408
    s_lshl_b32 s73, s72, 7
    s_add_u32 s15, s15, s73
    s_cmp_ge_u32 s2, 224
    s_cselect_b32 s58, 0, s58
    s_bitcmp1_b32 s2, 2
    s_cselect_b32 s56, s30, s28
    s_cselect_b32 s57, s31, s29
    s_mov_b32 s48, s38
    s_mov_b32 s49, s39
    s_mov_b32 s50, 5242880
    s_mov_b32 s51, 0x20000
    s_add_u32 s64, s3, s4
    s_and_b32 s64, s64, 3
    s_lshl_b32 s7, s5, 2
    s_add_u32 s7, s7, s64
    s_lshl_b32 s7, s7, 13
    s_add_u32 s7, s7, 7168
    s_add_u32 s64, s38, s7
    s_addc_u32 s65, s39, 0
    s_mov_b32 s66, 0
    s_mov_b32 s67, 0x20000
    s_lshl_b32 s68, s4, 4
    s_add_u32 s68, s68, s5
    s_and_b32 s69, s68, 127
    s_lshr_b32 s70, s68, 7
    s_lshl_b32 s68, s68, 13
    s_waitcnt vmcnt(12)
    s_and_b32 s100, s6, 4278583295
    s_and_b32 s101, s6, 131072
    s_lshl_b32 s101, s101, 4
    s_or_b32 s100, s100, s101
    s_and_b32 s101, s6, 524288
    s_lshr_b32 s101, s101, 2
    s_or_b32 s100, s100, s101
    s_and_b32 s101, s6, 1048576
    s_lshl_b32 s101, s101, 3
    s_or_b32 s100, s100, s101
    s_and_b32 s101, s6, 2097152
    s_lshl_b32 s101, s101, 1
    s_or_b32 s100, s100, s101
    s_and_b32 s101, s6, 12582912
    s_lshr_b32 s101, s101, 3
    s_or_b32 s100, s100, s101
    buffer_load_dwordx4 a[0:3], v1, s[40:43], s100 offen offset:0 nt
    buffer_load_dwordx4 a[4:7], v1, s[40:43], s100 offen offset:256 nt
    buffer_load_dwordx4 a[8:11], v1, s[40:43], s100 offen offset:2048 nt
    buffer_load_dwordx4 a[12:15], v1, s[40:43], s100 offen offset:2304 nt
    buffer_load_dwordx4 a[16:19], v2, s[40:43], s100 offen offset:0 nt
    buffer_load_dwordx4 a[20:23], v2, s[40:43], s100 offen offset:256 nt
    buffer_load_dwordx4 a[24:27], v2, s[40:43], s100 offen offset:2048 nt
    buffer_load_dwordx4 a[28:31], v2, s[40:43], s100 offen offset:2304 nt
    s_add_u32 s6, s6, 0x80000
    v_lshlrev_b32 v60, 16, v20
    v_and_b32 v61, 0xffff0000, v20
    v_lshlrev_b32 v62, 16, v21
    v_and_b32 v63, 0xffff0000, v21
    v_lshlrev_b32 v64, 16, v22
    v_and_b32 v65, 0xffff0000, v22
    v_lshlrev_b32 v66, 16, v23
    v_and_b32 v67, 0xffff0000, v23
    v_lshlrev_b32 v68, 16, v24
    v_and_b32 v69, 0xffff0000, v24
    v_lshlrev_b32 v70, 16, v25
    v_and_b32 v71, 0xffff0000, v25
    v_lshlrev_b32 v72, 16, v26
    v_and_b32 v73, 0xffff0000, v26
    s_mov_b32 s11, 0xc3e00000
    v_add_f32 v5, v60, v61
    v_add_f32 v6, v62, v63
    v_add_f32 v5, v5, v64
    v_add_f32 v6, v6, v65
    v_add_f32 v5, v5, v66
    v_add_f32 v6, v6, v67
    v_add_f32 v5, v5, v68
    v_add_f32 v6, v6, v69
    v_add_f32 v5, v5, v70
    v_add_f32 v6, v6, v71
    v_add_f32 v5, v5, v72
    v_add_f32 v6, v6, v73
    v_add_f32 v5, v5, v6
    s_nop 1
    v_add_f32_dpp v5, v5, v5 quad_perm:[1,0,3,2] row_mask:0xf bank_mask:0xf
    s_nop 1
    v_add_f32_dpp v5, v5, v5 quad_perm:[2,3,0,1] row_mask:0xf bank_mask:0xf
    s_nop 1
    v_add_f32_dpp v5, v5, v5 row_half_mirror row_mask:0xf bank_mask:0xf
    s_nop 1
    v_add_f32_dpp v5, v5, v5 row_mirror row_mask:0xf bank_mask:0xf
    v_mov_b32 v6, v5
    s_nop 1
    v_permlane16_swap_b32 v6, v5
    v_add_f32 v5, v5, v6
    v_mul_f32 v6, 0x3b124925, v5
    v_fma_f32 v5, v6, s11, v5
    v_fmac_f32 v6, 0x3b124925, v5
    v_mov_b32 v5, v6
    v_sub_f32 v8, v60, v5
    v_mul_f32 v6, v8, v8
    v_sub_f32 v8, v61, v5
    v_fmac_f32 v6, v8, v8
    v_sub_f32 v8, v62, v5
    v_fmac_f32 v6, v8, v8
    v_sub_f32 v8, v63, v5
    v_fmac_f32 v6, v8, v8
    v_sub_f32 v8, v64, v5
    v_fmac_f32 v6, v8, v8
    v_sub_f32 v8, v65, v5
    v_fmac_f32 v6, v8, v8
    v_sub_f32 v8, v66, v5
    v_fmac_f32 v6, v8, v8
    v_sub_f32 v8, v67, v5
    v_fmac_f32 v6, v8, v8
    v_sub_f32 v8, v68, v5
    v_fmac_f32 v6, v8, v8
    v_sub_f32 v8, v69, v5
    v_fmac_f32 v6, v8, v8
    v_sub_f32 v8, v70, v5
    v_fmac_f32 v6, v8, v8
    v_sub_f32 v8, v71, v5
    v_fmac_f32 v6, v8, v8
    v_sub_f32 v8, v72, v5
    v_fmac_f32 v6, v8, v8
    v_sub_f32 v8, v73, v5
    v_fmac_f32 v6, v8, v8
    s_nop 1
    v_add_f32_dpp v6, v6, v6 quad_perm:[1,0,3,2] row_mask:0xf bank_mask:0xf
    s_nop 1
    v_add_f32_dpp v6, v6, v6 quad_perm:[2,3,0,1] row_mask:0xf bank_mask:0xf
    s_nop 1
    v_add_f32_dpp v6, v6, v6 row_half_mirror row_mask:0xf bank_mask:0xf
    s_nop 1
    v_add_f32_dpp v6, v6, v6 row_mirror row_mask:0xf bank_mask:0xf
    v_mov_b32 v8, v6
    s_nop 1
    v_permlane16_swap_b32 v8, v6
    v_add_f32 v6, v6, v8
    v_mul_f32 v8, 0x3b124925, v6
    v_fma_f32 v6, v8, s11, v6
    v_fmac_f32 v8, 0x3b124925, v6
    v_mov_b32 v6, v8
    v_cvt_pk_bf16_f32 v5, v5, v6
    v_and_b32 v6, 0xffff0000, v5
    v_lshlrev_b32 v5, 16, v5
    v_add_f32 v6, 0x3727c5ac, v6
    v_cvt_pk_bf16_f32 v6, v6, v6
    v_lshlrev_b32 v6, 16, v6
    v_sqrt_f32 v6, v6
    s_nop 0
    v_cvt_pk_bf16_f32 v6, v6, v6
    v_lshlrev_b32 v6, 16, v6
    v_rcp_f32 v6, v6
    v_sub_f32 v60, v60, v5
    v_sub_f32 v61, v61, v5
    v_sub_f32 v62, v62, v5
    v_sub_f32 v63, v63, v5
    v_sub_f32 v64, v64, v5
    v_sub_f32 v65, v65, v5
    v_sub_f32 v66, v66, v5
    v_sub_f32 v67, v67, v5
    v_sub_f32 v68, v68, v5
    v_sub_f32 v69, v69, v5
    v_sub_f32 v70, v70, v5
    v_sub_f32 v71, v71, v5
    v_sub_f32 v72, v72, v5
    v_sub_f32 v73, v73, v5
    v_cvt_pk_bf16_f32 v20, v60, v61
    v_cvt_pk_bf16_f32 v21, v62, v63
    v_cvt_pk_bf16_f32 v22, v64, v65
    v_cvt_pk_bf16_f32 v23, v66, v67
    v_cvt_pk_bf16_f32 v24, v68, v69
    v_cvt_pk_bf16_f32 v25, v70, v71
    v_cvt_pk_bf16_f32 v26, v72, v73
    v_lshlrev_b32 v60, 16, v20
    v_and_b32 v61, 0xffff0000, v20
    v_lshlrev_b32 v62, 16, v21
    v_and_b32 v63, 0xffff0000, v21
    v_lshlrev_b32 v64, 16, v22
    v_and_b32 v65, 0xffff0000, v22
    v_lshlrev_b32 v66, 16, v23
    v_and_b32 v67, 0xffff0000, v23
    v_lshlrev_b32 v68, 16, v24
    v_and_b32 v69, 0xffff0000, v24
    v_lshlrev_b32 v70, 16, v25
    v_and_b32 v71, 0xffff0000, v25
    v_lshlrev_b32 v72, 16, v26
    v_and_b32 v73, 0xffff0000, v26
    v_mul_f32 v60, v60, v6
    v_mul_f32 v61, v61, v6
    v_mul_f32 v62, v62, v6
    v_mul_f32 v63, v63, v6
    v_mul_f32 v64, v64, v6
    v_mul_f32 v65, v65, v6
    v_mul_f32 v66, v66, v6
    v_mul_f32 v67, v67, v6
    v_mul_f32 v68, v68, v6
    v_mul_f32 v69, v69, v6
    v_mul_f32 v70, v70, v6
    v_mul_f32 v71, v71, v6
    v_mul_f32 v72, v72, v6
    v_mul_f32 v73, v73, v6
    v_cvt_pk_bf16_f32 v20, v60, v61
    v_cvt_pk_bf16_f32 v21, v62, v63
    v_cvt_pk_bf16_f32 v22, v64, v65
    v_cvt_pk_bf16_f32 v23, v66, v67
    v_cvt_pk_bf16_f32 v24, v68, v69
    v_cvt_pk_bf16_f32 v25, v70, v71
    v_cvt_pk_bf16_f32 v26, v72, v73
    v_lshlrev_b32 v60, 16, v20
    v_and_b32 v61, 0xffff0000, v20
    v_lshlrev_b32 v62, 16, v21
    v_and_b32 v63, 0xffff0000, v21
    v_lshlrev_b32 v64, 16, v22
    v_and_b32 v65, 0xffff0000, v22
    v_lshlrev_b32 v66, 16, v23
    v_and_b32 v67, 0xffff0000, v23
    v_lshlrev_b32 v68, 16, v24
    v_and_b32 v69, 0xffff0000, v24
    v_lshlrev_b32 v70, 16, v25
    v_and_b32 v71, 0xffff0000, v25
    v_lshlrev_b32 v72, 16, v26
    v_and_b32 v73, 0xffff0000, v26
    v_lshlrev_b32 v11, 1, v11
    ds_write_b64 v11, v[60:61] offset:16640
    ds_write_b64 v11, v[62:63] offset:16896
    ds_write_b64 v11, v[64:65] offset:17152
    ds_write_b64 v11, v[66:67] offset:17408
    ds_write_b64 v11, v[68:69] offset:17664
    ds_write_b64 v11, v[70:71] offset:17920
    ds_write_b64 v11, v[72:73] offset:18176
    v_lshlrev_b32 v12, 2, v12
    s_mul_i32 s7, s12, 448
    v_add_u32 v5, s7, v12
    s_mul_i32 s7, s71, 448
    v_add_u32 v6, s7, v12
    s_lshl_b32 s7, s3, 9
    v_bfe_u32 v8, v0, 4, 1
    v_lshlrev_b32 v14, 8, v8
    v_lshl_add_u32 v14, v13, 5, v14
    v_lshrrev_b32 v8, 5, v0
    v_lshl_add_u32 v14, v8, 4, v14
    v_add_u32 v14, s7, v14
    s_waitcnt lgkmcnt(0)
    ds_read_b32 v76, v5 offset:16640
    ds_read_b32 v77, v5 offset:16768
    ds_read_b32 v78, v5 offset:16896
    ds_read_b32 v79, v5 offset:17024
    ds_read_b32 v80, v5 offset:18432
    ds_read_b32 v81, v5 offset:18560
    ds_read_b32 v82, v5 offset:18688
    ds_read_b32 v83, v5 offset:18816
    ds_read_b32 v84, v6 offset:16640
    ds_read_b32 v85, v6 offset:16768
    ds_read_b32 v86, v6 offset:16896
    ds_read_b32 v87, v6 offset:17024
    ds_read_b32 v88, v6 offset:18432
    ds_read_b32 v89, v6 offset:18560
    ds_read_b32 v90, v6 offset:18688
    ds_read_b32 v91, v6 offset:18816
    s_and_b32 s100, s6, 4278583295
    s_and_b32 s101, s6, 131072
    s_lshl_b32 s101, s101, 4
    s_or_b32 s100, s100, s101
    s_and_b32 s101, s6, 524288
    s_lshr_b32 s101, s101, 2
    s_or_b32 s100, s100, s101
    s_and_b32 s101, s6, 1048576
    s_lshl_b32 s101, s101, 3
    s_or_b32 s100, s100, s101
    s_and_b32 s101, s6, 2097152
    s_lshl_b32 s101, s101, 1
    s_or_b32 s100, s100, s101
    s_and_b32 s101, s6, 12582912
    s_lshr_b32 s101, s101, 3
    s_or_b32 s100, s100, s101
    buffer_load_dwordx4 a[32:35], v1, s[40:43], s100 offen offset:0 nt
    buffer_load_dwordx4 a[36:39], v1, s[40:43], s100 offen offset:256 nt
    buffer_load_dwordx4 a[40:43], v1, s[40:43], s100 offen offset:2048 nt
    buffer_load_dwordx4 a[44:47], v1, s[40:43], s100 offen offset:2304 nt
    buffer_load_dwordx4 a[48:51], v2, s[40:43], s100 offen offset:0 nt
    buffer_load_dwordx4 a[52:55], v2, s[40:43], s100 offen offset:256 nt
    buffer_load_dwordx4 a[56:59], v2, s[40:43], s100 offen offset:2048 nt
    buffer_load_dwordx4 a[60:63], v2, s[40:43], s100 offen offset:2304 nt
    s_add_u32 s6, s6, 0x80000
    s_add_u32 s97, s97, 1
    s_waitcnt lgkmcnt(0)
    s_waitcnt vmcnt(27)
    v_lshlrev_b32 v108, 16, v28
    v_and_b32 v109, 0xffff0000, v28
    v_lshlrev_b32 v110, 16, v29
    v_and_b32 v111, 0xffff0000, v29
    v_lshlrev_b32 v112, 16, v30
    v_and_b32 v113, 0xffff0000, v30
    v_lshlrev_b32 v114, 16, v31
    v_and_b32 v115, 0xffff0000, v31
    v_mul_f32 v92, v76, v108
    v_mul_f32 v93, v76, v109
    v_mul_f32 v94, v76, v110
    v_mul_f32 v95, v76, v111
    v_mul_f32 v96, v76, v112
    v_mul_f32 v97, v76, v113
    v_mul_f32 v98, v76, v114
    v_mul_f32 v99, v76, v115
    v_mul_f32 v100, v80, v108
    v_mul_f32 v101, v80, v109
    v_mul_f32 v102, v80, v110
    v_mul_f32 v103, v80, v111
    v_mul_f32 v104, v80, v112
    v_mul_f32 v105, v80, v113
    v_mul_f32 v106, v80, v114
    v_mul_f32 v107, v80, v115
    s_waitcnt vmcnt(26)
    v_lshlrev_b32 v108, 16, v32
    v_and_b32 v109, 0xffff0000, v32
    v_lshlrev_b32 v110, 16, v33
    v_and_b32 v111, 0xffff0000, v33
    v_lshlrev_b32 v112, 16, v34
    v_and_b32 v113, 0xffff0000, v34
    v_lshlrev_b32 v114, 16, v35
    v_and_b32 v115, 0xffff0000, v35
    v_fmac_f32 v92, v77, v108
    v_fmac_f32 v93, v77, v109
    v_fmac_f32 v94, v77, v110
    v_fmac_f32 v95, v77, v111
    v_fmac_f32 v96, v77, v112
    v_fmac_f32 v97, v77, v113
    v_fmac_f32 v98, v77, v114
    v_fmac_f32 v99, v77, v115
    v_fmac_f32 v100, v81, v108
    v_fmac_f32 v101, v81, v109
    v_fmac_f32 v102, v81, v110
    v_fmac_f32 v103, v81, v111
    v_fmac_f32 v104, v81, v112
    v_fmac_f32 v105, v81, v113
    v_fmac_f32 v106, v81, v114
    v_fmac_f32 v107, v81, v115
    s_waitcnt vmcnt(25)
    v_lshlrev_b32 v108, 16, v36
    v_and_b32 v109, 0xffff0000, v36
    v_lshlrev_b32 v110, 16, v37
    v_and_b32 v111, 0xffff0000, v37
    v_lshlrev_b32 v112, 16, v38
    v_and_b32 v113, 0xffff0000, v38
    v_lshlrev_b32 v114, 16, v39
    v_and_b32 v115, 0xffff0000, v39
    v_fmac_f32 v92, v78, v108
    v_fmac_f32 v93, v78, v109
    v_fmac_f32 v94, v78, v110
    v_fmac_f32 v95, v78, v111
    v_fmac_f32 v96, v78, v112
    v_fmac_f32 v97, v78, v113
    v_fmac_f32 v98, v78, v114
    v_fmac_f32 v99, v78, v115
    v_fmac_f32 v100, v82, v108
    v_fmac_f32 v101, v82, v109
    v_fmac_f32 v102, v82, v110
    v_fmac_f32 v103, v82, v111
    v_fmac_f32 v104, v82, v112
    v_fmac_f32 v105, v82, v113
    v_fmac_f32 v106, v82, v114
    v_fmac_f32 v107, v82, v115
    s_cmp_ge_u32 s3, 2
    s_nop 0
    s_cbranch_scc1 L_ecode_kernel_u3wq
    s_waitcnt vmcnt(24)
    v_lshlrev_b32 v108, 16, v40
    v_and_b32 v109, 0xffff0000, v40
    v_lshlrev_b32 v110, 16, v41
    v_and_b32 v111, 0xffff0000, v41
    v_lshlrev_b32 v112, 16, v42
    v_and_b32 v113, 0xffff0000, v42
    v_lshlrev_b32 v114, 16, v43
    v_and_b32 v115, 0xffff0000, v43
    v_fmac_f32 v92, v79, v108
    v_fmac_f32 v93, v79, v109
    v_fmac_f32 v94, v79, v110
    v_fmac_f32 v95, v79, v111
    v_fmac_f32 v96, v79, v112
    v_fmac_f32 v97, v79, v113
    v_fmac_f32 v98, v79, v114
    v_fmac_f32 v99, v79, v115
    v_fmac_f32 v100, v83, v108
    v_fmac_f32 v101, v83, v109
    v_fmac_f32 v102, v83, v110
    v_fmac_f32 v103, v83, v111
    v_fmac_f32 v104, v83, v112
    v_fmac_f32 v105, v83, v113
    v_fmac_f32 v106, v83, v114
    v_fmac_f32 v107, v83, v115
L_ecode_kernel_u3wq:
    v_permlane16_swap_b32 v92, v100
    v_permlane16_swap_b32 v93, v101
    v_permlane16_swap_b32 v94, v102
    v_permlane16_swap_b32 v95, v103
    v_permlane16_swap_b32 v96, v104
    v_permlane16_swap_b32 v97, v105
    v_permlane16_swap_b32 v98, v106
    v_permlane16_swap_b32 v99, v107
    v_add_f32 v92, v92, v100
    v_add_f32 v93, v93, v101
    v_add_f32 v94, v94, v102
    v_add_f32 v95, v95, v103
    v_add_f32 v96, v96, v104
    v_add_f32 v97, v97, v105
    v_add_f32 v98, v98, v106
    v_add_f32 v99, v99, v107
    v_permlane32_swap_b32 v92, v96
    v_permlane32_swap_b32 v93, v97
    v_permlane32_swap_b32 v94, v98
    v_permlane32_swap_b32 v95, v99
    v_add_f32 v92, v92, v96
    v_add_f32 v93, v93, v97
    v_add_f32 v94, v94, v98
    v_add_f32 v95, v95, v99
    v_add_f32_dpp v92, v92, v92 row_ror:8 row_mask:0xf bank_mask:0xf
    v_add_f32_dpp v93, v93, v93 row_ror:8 row_mask:0xf bank_mask:0xf
    v_add_f32_dpp v94, v94, v94 row_ror:8 row_mask:0xf bank_mask:0xf
    v_add_f32_dpp v95, v95, v95 row_ror:8 row_mask:0xf bank_mask:0xf
    ds_write_b128 v14, v[92:95] offset:20224
    v_mov_b32 v117, s97
    v_mov_b32 v119, s97
    v_lshrrev_b32 v6, 5, v0
    v_lshlrev_b32 v6, 15, v6
    v_and_b32 v5, 31, v0
    v_lshl_add_u32 v6, v5, 4, v6
    s_lshl_b32 s7, s12, 16
    s_lshl_b32 s13, s13, 9
    s_add_u32 s7, s7, s13
    s_add_u32 s7, s7, 2097152
    s_waitcnt lgkmcnt(0)
    s_barrier
    s_cmp_lg_u32 s3, 0
    s_cbranch_scc1 L_ecode_kernel_pubwait
    v_lshlrev_b32 v5, 3, v0
    ds_read_b64 v[108:109], v5 offset:20224
    ds_read_b64 v[110:111], v5 offset:20736
    ds_read_b64 v[112:113], v5 offset:21248
    ds_read_b64 v[114:115], v5 offset:21760
    s_waitcnt lgkmcnt(0)
    v_add_f32 v108, v108, v110
    v_add_f32 v109, v109, v111
    v_add_f32 v112, v112, v114
    v_add_f32 v113, v113, v115
    v_add_f32 v116, v108, v112
    v_add_f32 v118, v109, v113
    buffer_store_dwordx4 v[116:119], v6, s[48:51], s7 offen sc1
L_ecode_kernel_pubwait:
    s_nop 1
    s_barrier
    buffer_load_dwordx4 v[44:47], v9, s[56:59], s15 offen nt
    s_add_u32 s15, s15, 114688
    buffer_load_dwordx4 v[48:51], v9, s[56:59], s15 offen nt
    s_add_u32 s15, s15, 114688
    buffer_load_dwordx4 v[52:55], v9, s[56:59], s15 offen nt
    s_add_u32 s15, s15, 114688
    s_cmp_ge_u32 s3, 2
    s_cselect_b32 s15, 0x7fff0000, s15
    buffer_load_dwordx4 v[56:59], v9, s[56:59], s15 offen nt
    s_lshl_b32 s12, s4, 12
    s_lshl_b32 s13, s3, 10
    s_add_u32 s12, s12, s13
    s_add_u32 s12, s12, 2097152
    s_add_u32 s13, s12, 0x10000
    s_add_u32 s14, s12, 0x20000
    s_add_u32 s15, s12, 0x30000
    v_lshlrev_b32 v9, 4, v0
    s_and_b32 s100, s6, 4278583295
    s_and_b32 s101, s6, 131072
    s_lshl_b32 s101, s101, 4
    s_or_b32 s100, s100, s101
    s_and_b32 s101, s6, 524288
    s_lshr_b32 s101, s101, 2
    s_or_b32 s100, s100, s101
    s_and_b32 s101, s6, 1048576
    s_lshl_b32 s101, s101, 3
    s_or_b32 s100, s100, s101
    s_and_b32 s101, s6, 2097152
    s_lshl_b32 s101, s101, 1
    s_or_b32 s100, s100, s101
    s_and_b32 s101, s6, 12582912
    s_lshr_b32 s101, s101, 3
    s_or_b32 s100, s100, s101
    buffer_load_dwordx4 a[64:67], v1, s[40:43], s100 offen offset:0 nt
    buffer_load_dwordx4 a[68:71], v1, s[40:43], s100 offen offset:256 nt
    buffer_load_dwordx4 a[72:75], v1, s[40:43], s100 offen offset:2048 nt
    buffer_load_dwordx4 a[76:79], v1, s[40:43], s100 offen offset:2304 nt
    buffer_load_dwordx4 a[80:83], v2, s[40:43], s100 offen offset:0 nt
    buffer_load_dwordx4 a[84:87], v2, s[40:43], s100 offen offset:256 nt
    buffer_load_dwordx4 a[88:91], v2, s[40:43], s100 offen offset:2048 nt
    buffer_load_dwordx4 a[92:95], v2, s[40:43], s100 offen offset:2304 nt
    s_add_u32 s6, s6, 0x80000
    s_and_b32 s100, s6, 4278583295
    s_and_b32 s101, s6, 131072
    s_lshl_b32 s101, s101, 4
    s_or_b32 s100, s100, s101
    s_and_b32 s101, s6, 524288
    s_lshr_b32 s101, s101, 2
    s_or_b32 s100, s100, s101
    s_and_b32 s101, s6, 1048576
    s_lshl_b32 s101, s101, 3
    s_or_b32 s100, s100, s101
    s_and_b32 s101, s6, 2097152
    s_lshl_b32 s101, s101, 1
    s_or_b32 s100, s100, s101
    s_and_b32 s101, s6, 12582912
    s_lshr_b32 s101, s101, 3
    s_or_b32 s100, s100, s101
    buffer_load_dwordx4 a[96:99], v1, s[40:43], s100 offen offset:0 nt
    buffer_load_dwordx4 a[100:103], v1, s[40:43], s100 offen offset:256 nt
    buffer_load_dwordx4 a[104:107], v1, s[40:43], s100 offen offset:2048 nt
    buffer_load_dwordx4 a[108:111], v1, s[40:43], s100 offen offset:2304 nt
    buffer_load_dwordx4 a[112:115], v2, s[40:43], s100 offen offset:0 nt
    buffer_load_dwordx4 a[116:119], v2, s[40:43], s100 offen offset:256 nt
    buffer_load_dwordx4 a[120:123], v2, s[40:43], s100 offen offset:2048 nt
    buffer_load_dwordx4 a[124:127], v2, s[40:43], s100 offen offset:2304 nt
    s_add_u32 s6, s6, 0x80000
    s_and_b32 s100, s6, 4278583295
    s_and_b32 s101, s6, 131072
    s_lshl_b32 s101, s101, 4
    s_or_b32 s100, s100, s101
    s_and_b32 s101, s6, 524288
    s_lshr_b32 s101, s101, 2
    s_or_b32 s100, s100, s101
    s_and_b32 s101, s6, 1048576
    s_lshl_b32 s101, s101, 3
    s_or_b32 s100, s100, s101
    s_and_b32 s101, s6, 2097152
    s_lshl_b32 s101, s101, 1
    s_or_b32 s100, s100, s101
    s_and_b32 s101, s6, 12582912
    s_lshr_b32 s101, s101, 3
    s_or_b32 s100, s100, s101
    buffer_load_dwordx4 a[128:131], v1, s[40:43], s100 offen offset:0 nt
    s_waitcnt vmcnt(40)
    buffer_load_dwordx4 a[132:135], v1, s[40:43], s100 offen offset:256 nt
    buffer_load_dwordx4 a[136:139], v1, s[40:43], s100 offen offset:2048 nt
    buffer_load_dwordx4 a[140:143], v1, s[40:43], s100 offen offset:2304 nt
    buffer_load_dwordx4 a[144:147], v2, s[40:43], s100 offen offset:0 nt
    buffer_load_dwordx4 a[148:151], v2, s[40:43], s100 offen offset:256 nt
    buffer_load_dwordx4 a[152:155], v2, s[40:43], s100 offen offset:2048 nt
    buffer_load_dwordx4 a[156:159], v2, s[40:43], s100 offen offset:2304 nt
    s_add_u32 s6, s6, 0x80000
    buffer_load_dwordx4 v[28:31], v9, s[48:51], s12 offen sc1
    buffer_load_dwordx4 v[32:35], v9, s[48:51], s13 offen sc1
    buffer_load_dwordx4 v[36:39], v9, s[48:51], s14 offen sc1
    buffer_load_dwordx4 v[40:43], v9, s[48:51], s15 offen sc1
    s_and_b32 s100, s6, 4278583295
    s_and_b32 s101, s6, 131072
    s_lshl_b32 s101, s101, 4
    s_or_b32 s100, s100, s101
    s_and_b32 s101, s6, 524288
    s_lshr_b32 s101, s101, 2
    s_or_b32 s100, s100, s101
    s_and_b32 s101, s6, 1048576
    s_lshl_b32 s101, s101, 3
    s_or_b32 s100, s100, s101
    s_and_b32 s101, s6, 2097152
    s_lshl_b32 s101, s101, 1
    s_or_b32 s100, s100, s101
    s_and_b32 s101, s6, 12582912
    s_lshr_b32 s101, s101, 3
    s_or_b32 s100, s100, s101
    buffer_load_dwordx4 a[160:163], v1, s[40:43], s100 offen offset:0 nt
    buffer_load_dwordx4 a[164:167], v1, s[40:43], s100 offen offset:256 nt
    buffer_load_dwordx4 a[168:171], v1, s[40:43], s100 offen offset:2048 nt
    buffer_load_dwordx4 a[172:175], v1, s[40:43], s100 offen offset:2304 nt
    buffer_load_dwordx4 a[176:179], v2, s[40:43], s100 offen offset:0 nt
    s_waitcnt vmcnt(40)
    buffer_load_dwordx4 a[180:183], v2, s[40:43], s100 offen offset:256 nt
    buffer_load_dwordx4 a[184:187], v2, s[40:43], s100 offen offset:2048 nt
    buffer_load_dwordx4 a[188:191], v2, s[40:43], s100 offen offset:2304 nt
    s_add_u32 s6, s6, 0x80000
    s_and_b32 s100, s6, 4278583295
    s_and_b32 s101, s6, 131072
    s_lshl_b32 s101, s101, 4
    s_or_b32 s100, s100, s101
    s_and_b32 s101, s6, 524288
    s_lshr_b32 s101, s101, 2
    s_or_b32 s100, s100, s101
    s_and_b32 s101, s6, 1048576
    s_lshl_b32 s101, s101, 3
    s_or_b32 s100, s100, s101
    s_and_b32 s101, s6, 2097152
    s_lshl_b32 s101, s101, 1
    s_or_b32 s100, s100, s101
    s_and_b32 s101, s6, 12582912
    s_lshr_b32 s101, s101, 3
    s_or_b32 s100, s100, s101
    buffer_load_dwordx4 a[192:195], v1, s[40:43], s100 offen offset:0 nt
    buffer_load_dwordx4 a[196:199], v1, s[40:43], s100 offen offset:256 nt
    buffer_load_dwordx4 a[200:203], v1, s[40:43], s100 offen offset:2048 nt
    buffer_load_dwordx4 a[204:207], v1, s[40:43], s100 offen offset:2304 nt
    buffer_load_dwordx4 a[208:211], v2, s[40:43], s100 offen offset:0 nt
    buffer_load_dwordx4 a[212:215], v2, s[40:43], s100 offen offset:256 nt
    buffer_load_dwordx4 a[216:219], v2, s[40:43], s100 offen offset:2048 nt
    buffer_load_dwordx4 a[220:223], v2, s[40:43], s100 offen offset:2304 nt
    s_add_u32 s6, s6, 0x80000
    s_waitcnt vmcnt(47)
    v_lshlrev_b32 v108, 16, v44
    v_and_b32 v109, 0xffff0000, v44
    v_lshlrev_b32 v110, 16, v45
    v_and_b32 v111, 0xffff0000, v45
    v_lshlrev_b32 v112, 16, v46
    v_and_b32 v113, 0xffff0000, v46
    v_lshlrev_b32 v114, 16, v47
    v_and_b32 v115, 0xffff0000, v47
    v_mul_f32 v92, v84, v108
    v_mul_f32 v93, v84, v109
    v_mul_f32 v94, v84, v110
    v_mul_f32 v95, v84, v111
    v_mul_f32 v96, v84, v112
    v_mul_f32 v97, v84, v113
    v_mul_f32 v98, v84, v114
    v_mul_f32 v99, v84, v115
    v_mul_f32 v100, v88, v108
    v_mul_f32 v101, v88, v109
    v_mul_f32 v102, v88, v110
    v_mul_f32 v103, v88, v111
    v_mul_f32 v104, v88, v112
    v_mul_f32 v105, v88, v113
    v_mul_f32 v106, v88, v114
    v_mul_f32 v107, v88, v115
    s_waitcnt vmcnt(46)
    v_lshlrev_b32 v108, 16, v48
    v_and_b32 v109, 0xffff0000, v48
    v_lshlrev_b32 v110, 16, v49
    v_and_b32 v111, 0xffff0000, v49
    v_lshlrev_b32 v112, 16, v50
    v_and_b32 v113, 0xffff0000, v50
    v_lshlrev_b32 v114, 16, v51
    v_and_b32 v115, 0xffff0000, v51
    v_fmac_f32 v92, v85, v108
    v_fmac_f32 v93, v85, v109
    v_fmac_f32 v94, v85, v110
    v_fmac_f32 v95, v85, v111
    v_fmac_f32 v96, v85, v112
    v_fmac_f32 v97, v85, v113
    v_fmac_f32 v98, v85, v114
    v_fmac_f32 v99, v85, v115
    v_fmac_f32 v100, v89, v108
    v_fmac_f32 v101, v89, v109
    v_fmac_f32 v102, v89, v110
    v_fmac_f32 v103, v89, v111
    v_fmac_f32 v104, v89, v112
    v_fmac_f32 v105, v89, v113
    v_fmac_f32 v106, v89, v114
    v_fmac_f32 v107, v89, v115
    s_waitcnt vmcnt(45)
    v_lshlrev_b32 v108, 16, v52
    v_and_b32 v109, 0xffff0000, v52
    v_lshlrev_b32 v110, 16, v53
    v_and_b32 v111, 0xffff0000, v53
    v_lshlrev_b32 v112, 16, v54
    v_and_b32 v113, 0xffff0000, v54
    v_lshlrev_b32 v114, 16, v55
    v_and_b32 v115, 0xffff0000, v55
    v_fmac_f32 v92, v86, v108
    v_fmac_f32 v93, v86, v109
    v_fmac_f32 v94, v86, v110
    v_fmac_f32 v95, v86, v111
    v_fmac_f32 v96, v86, v112
    v_fmac_f32 v97, v86, v113
    v_fmac_f32 v98, v86, v114
    v_fmac_f32 v99, v86, v115
    v_fmac_f32 v100, v90, v108
    v_fmac_f32 v101, v90, v109
    v_fmac_f32 v102, v90, v110
    v_fmac_f32 v103, v90, v111
    v_fmac_f32 v104, v90, v112
    v_fmac_f32 v105, v90, v113
    v_fmac_f32 v106, v90, v114
    v_fmac_f32 v107, v90, v115
    s_cmp_ge_u32 s3, 2
    s_nop 0
    s_cbranch_scc1 L_ecode_kernel_u3wf
    s_waitcnt vmcnt(44)
    v_lshlrev_b32 v108, 16, v56
    v_and_b32 v109, 0xffff0000, v56
    v_lshlrev_b32 v110, 16, v57
    v_and_b32 v111, 0xffff0000, v57
    v_lshlrev_b32 v112, 16, v58
    v_and_b32 v113, 0xffff0000, v58
    v_lshlrev_b32 v114, 16, v59
    v_and_b32 v115, 0xffff0000, v59
    v_fmac_f32 v92, v87, v108
    v_fmac_f32 v93, v87, v109
    v_fmac_f32 v94, v87, v110
    v_fmac_f32 v95, v87, v111
    v_fmac_f32 v96, v87, v112
    v_fmac_f32 v97, v87, v113
    v_fmac_f32 v98, v87, v114
    v_fmac_f32 v99, v87, v115
    v_fmac_f32 v100, v91, v108
    v_fmac_f32 v101, v91, v109
    v_fmac_f32 v102, v91, v110
    v_fmac_f32 v103, v91, v111
    v_fmac_f32 v104, v91, v112
    v_fmac_f32 v105, v91, v113
    v_fmac_f32 v106, v91, v114
    v_fmac_f32 v107, v91, v115
L_ecode_kernel_u3wf:
    v_permlane16_swap_b32 v92, v100
    v_permlane16_swap_b32 v93, v101
    v_permlane16_swap_b32 v94, v102
    v_permlane16_swap_b32 v95, v103
    v_permlane16_swap_b32 v96, v104
    v_permlane16_swap_b32 v97, v105
    v_permlane16_swap_b32 v98, v106
    v_permlane16_swap_b32 v99, v107
    v_add_f32 v92, v92, v100
    v_add_f32 v93, v93, v101
    v_add_f32 v94, v94, v102
    v_add_f32 v95, v95, v103
    v_add_f32 v96, v96, v104
    v_add_f32 v97, v97, v105
    v_add_f32 v98, v98, v106
    v_add_f32 v99, v99, v107
    v_permlane32_swap_b32 v92, v96
    v_permlane32_swap_b32 v93, v97
    v_permlane32_swap_b32 v94, v98
    v_permlane32_swap_b32 v95, v99
    v_add_f32 v92, v92, v96
    v_add_f32 v93, v93, v97
    v_add_f32 v94, v94, v98
    v_add_f32 v95, v95, v99
    v_add_f32_dpp v92, v92, v92 row_ror:8 row_mask:0xf bank_mask:0xf
    v_add_f32_dpp v93, v93, v93 row_ror:8 row_mask:0xf bank_mask:0xf
    v_add_f32_dpp v94, v94, v94 row_ror:8 row_mask:0xf bank_mask:0xf
    v_add_f32_dpp v95, v95, v95 row_ror:8 row_mask:0xf bank_mask:0xf
    ds_write_b128 v14, v[92:95] offset:22272
    v_and_b32 v7, 1, v0
    v_cmp_eq_u32 vcc, 1, v7
    v_mov_b32 v8, 0xffff
    v_mov_b32 v11, 0xffff0000
    v_cndmask_b32 v8, v8, v11, vcc
    v_bfe_u32 v7, v0, 1, 2
    v_cmp_eq_u32 vcc, 0, v7
    s_nop 1
    v_cndmask_b32 v16, 0, v8, vcc
    v_cmp_eq_u32 vcc, 1, v7
    s_nop 1
    v_cndmask_b32 v17, 0, v8, vcc
    v_cmp_eq_u32 vcc, 2, v7
    s_nop 1
    v_cndmask_b32 v18, 0, v8, vcc
    v_cmp_eq_u32 vcc, 3, v7
    s_nop 1
    v_cndmask_b32 v19, 0, v8, vcc
    v_lshrrev_b32 v7, 2, v0
    v_xor_b32 v7, v7, v0
    v_and_b32 v7, 8, v7
    v_cmp_ne_u32 s[8:9], 0, v7
    s_mov_b32 s10, 0x3db8aa3b
    s_mov_b32 s11, 0
    s_mov_b32 s98, 1
    s_mov_b32 s73, 0
    s_lshl_b32 s7, s3, 8
    v_lshlrev_b32 v13, 2, v0
    v_add_u32 v13, s7, v13
    s_mov_b32 s44, 0x01010101
    s_mov_b32 s45, 0x01010101
    s_waitcnt vmcnt(16)
L_ecode_kernel_qchk:
    v_xor_b32 v7, s97, v29
    v_xor_b32 v8, s97, v31
    v_xor_b32 v11, s97, v33
    v_xor_b32 v12, s97, v35
    v_or3_b32 v7, v7, v11, v12
    v_xor_b32 v11, s97, v37
    v_xor_b32 v12, s97, v39
    v_or3_b32 v7, v7, v11, v12
    v_xor_b32 v11, s97, v41
    v_xor_b32 v12, s97, v43
    v_or3_b32 v7, v7, v11, v12
    v_or_b32 v7, v7, v8
    v_cmp_ne_u32 vcc, 0, v7
    s_nop 4
    s_cbranch_vccz L_ecode_kernel_qok
    s_add_u32 s73, s73, 1
    s_cmp_ge_u32 s73, 524288
    s_cbranch_scc1 L_ecode_kernel_qok
    buffer_load_dwordx4 v[28:31], v9, s[48:51], s12 offen sc1
    buffer_load_dwordx4 v[32:35], v9, s[48:51], s13 offen sc1
    buffer_load_dwordx4 v[36:39], v9, s[48:51], s14 offen sc1
    buffer_load_dwordx4 v[40:43], v9, s[48:51], s15 offen sc1
    s_waitcnt vmcnt(0)
    s_branch L_ecode_kernel_qchk
L_ecode_kernel_qok:
    v_add_f32 v28, v28, v32
    v_add_f32 v30, v30, v34
    v_add_f32 v36, v36, v40
    v_add_f32 v38, v38, v42
    v_add_f32 v28, v28, v36
    v_add_f32 v30, v30, v38
    v_cvt_pk_bf16_f32 v7, v28, v30
    ds_write_b32 v13, v7 offset:24576
    v_mov_b32 v8, 0
    ds_write_b32 v8, v8 offset:33792
    s_waitcnt lgkmcnt(0)
    s_barrier
    ds_read_b128 v[20:23], v15 offset:24576
    ds_read_b128 v[24:27], v15 offset:24832
    v_lshrrev_b32 v15, 3, v0
    v_lshlrev_b32 v15, 3, v15
    s_lshl_b32 s7, s3, 11
    v_add_u32 v14, s7, v15
    s_waitcnt lgkmcnt(0)
    s_and_b32 s100, s6, 4278583295
    s_and_b32 s101, s6, 131072
    s_lshl_b32 s101, s101, 4
    s_or_b32 s100, s100, s101
    s_and_b32 s101, s6, 524288
    s_lshr_b32 s101, s101, 2
    s_or_b32 s100, s100, s101
    s_and_b32 s101, s6, 1048576
    s_lshl_b32 s101, s101, 3
    s_or_b32 s100, s100, s101
    s_and_b32 s101, s6, 2097152
    s_lshl_b32 s101, s101, 1
    s_or_b32 s100, s100, s101
    s_and_b32 s101, s6, 12582912
    s_lshr_b32 s101, s101, 3
    s_or_b32 s100, s100, s101
    v_mfma_f32_16x16x32_bf16 v[36:39], v[128:131], v[20:23], 0
    buffer_load_dwordx4 v[128:131], v1, s[40:43], s100 offen offset:0 nt
    v_mfma_f32_16x16x32_bf16 v[36:39], v[132:135], v[24:27], v[36:39]
    buffer_load_dwordx4 v[132:135], v1, s[40:43], s100 offen offset:256 nt
    v_mfma_f32_16x16x32_bf16 v[40:43], v[136:139], v[20:23], 0
    buffer_load_dwordx4 v[136:139], v1, s[40:43], s100 offen offset:2048 nt
    v_mfma_f32_16x16x32_bf16 v[40:43], v[140:143], v[24:27], v[40:43]
    buffer_load_dwordx4 v[140:143], v1, s[40:43], s100 offen offset:2304 nt
    v_mfma_f32_16x16x32_bf16 v[44:47], v[144:147], v[20:23], 0
    buffer_load_dwordx4 v[144:147], v2, s[40:43], s100 offen offset:0 nt
    v_mfma_f32_16x16x32_bf16 v[44:47], v[148:151], v[24:27], v[44:47]
    buffer_load_dwordx4 v[148:151], v2, s[40:43], s100 offen offset:256 nt
    v_mfma_f32_16x16x32_bf16 v[48:51], v[152:155], v[20:23], 0
    buffer_load_dwordx4 v[152:155], v2, s[40:43], s100 offen offset:2048 nt
    v_mfma_f32_16x16x32_bf16 v[48:51], v[156:159], v[24:27], v[48:51]
    buffer_load_dwordx4 v[156:159], v2, s[40:43], s100 offen offset:2304 nt
    v_mov_b32_dpp v60, v36 quad_perm:[0,0,0,0] row_mask:0xf bank_mask:0xf
    v_add_f32_dpp v60, v37, v60 quad_perm:[1,1,1,1] row_mask:0xf bank_mask:0xf
    v_add_f32_dpp v60, v38, v60 quad_perm:[2,2,2,2] row_mask:0xf bank_mask:0xf
    v_add_f32_dpp v60, v39, v60 quad_perm:[3,3,3,3] row_mask:0xf bank_mask:0xf
    v_mov_b32_dpp v61, v40 quad_perm:[0,0,0,0] row_mask:0xf bank_mask:0xf
    v_add_f32_dpp v61, v41, v61 quad_perm:[1,1,1,1] row_mask:0xf bank_mask:0xf
    v_add_f32_dpp v61, v42, v61 quad_perm:[2,2,2,2] row_mask:0xf bank_mask:0xf
    v_add_f32_dpp v61, v43, v61 quad_perm:[3,3,3,3] row_mask:0xf bank_mask:0xf
    v_mov_b32_dpp v62, v44 quad_perm:[0,0,0,0] row_mask:0xf bank_mask:0xf
    v_add_f32_dpp v62, v45, v62 quad_perm:[1,1,1,1] row_mask:0xf bank_mask:0xf
    v_add_f32_dpp v62, v46, v62 quad_perm:[2,2,2,2] row_mask:0xf bank_mask:0xf
    v_add_f32_dpp v62, v47, v62 quad_perm:[3,3,3,3] row_mask:0xf bank_mask:0xf
    v_mov_b32_dpp v63, v48 quad_perm:[0,0,0,0] row_mask:0xf bank_mask:0xf
    v_add_f32_dpp v63, v49, v63 quad_perm:[1,1,1,1] row_mask:0xf bank_mask:0xf
    v_add_f32_dpp v63, v50, v63 quad_perm:[2,2,2,2] row_mask:0xf bank_mask:0xf
    v_add_f32_dpp v63, v51, v63 quad_perm:[3,3,3,3] row_mask:0xf bank_mask:0xf
    v_cvt_pk_bf16_f32 v52, v60, v61
    v_cvt_pk_bf16_f32 v53, v62, v63
    s_mov_b64 exec, s[44:45]
    ds_write_b64 v14, v[52:53] offset:25600
    s_mov_b64 exec, -1
    v_add_u32 v14, 64, v14
    s_add_u32 s6, s6, 0x80000
    s_add_u32 s11, s11, 1
    v_mfma_f32_16x16x32_bf16 v[36:39], a[0:3], v[20:23], 0
    v_mfma_f32_16x16x32_bf16 v[36:39], a[4:7], v[24:27], v[36:39]
    v_mfma_f32_16x16x32_bf16 v[40:43], a[8:11], v[20:23], 0
    v_mfma_f32_16x16x32_bf16 v[40:43], a[12:15], v[24:27], v[40:43]
    v_mfma_f32_16x16x32_bf16 v[44:47], a[16:19], v[20:23], 0
    v_mfma_f32_16x16x32_bf16 v[44:47], a[20:23], v[24:27], v[44:47]
    v_mfma_f32_16x16x32_bf16 v[48:51], a[24:27], v[20:23], 0
    v_mfma_f32_16x16x32_bf16 v[48:51], a[28:31], v[24:27], v[48:51]
    s_nop 1
    v_mov_b32_dpp v60, v36 quad_perm:[0,0,0,0] row_mask:0xf bank_mask:0xf
    v_add_f32_dpp v60, v37, v60 quad_perm:[1,1,1,1] row_mask:0xf bank_mask:0xf
    v_add_f32_dpp v60, v38, v60 quad_perm:[2,2,2,2] row_mask:0xf bank_mask:0xf
    v_add_f32_dpp v60, v39, v60 quad_perm:[3,3,3,3] row_mask:0xf bank_mask:0xf
    v_mov_b32_dpp v61, v40 quad_perm:[0,0,0,0] row_mask:0xf bank_mask:0xf
    v_add_f32_dpp v61, v41, v61 quad_perm:[1,1,1,1] row_mask:0xf bank_mask:0xf
    v_add_f32_dpp v61, v42, v61 quad_perm:[2,2,2,2] row_mask:0xf bank_mask:0xf
    v_add_f32_dpp v61, v43, v61 quad_perm:[3,3,3,3] row_mask:0xf bank_mask:0xf
    v_mov_b32_dpp v62, v44 quad_perm:[0,0,0,0] row_mask:0xf bank_mask:0xf
    v_add_f32_dpp v62, v45, v62 quad_perm:[1,1,1,1] row_mask:0xf bank_mask:0xf
    v_add_f32_dpp v62, v46, v62 quad_perm:[2,2,2,2] row_mask:0xf bank_mask:0xf
    v_add_f32_dpp v62, v47, v62 quad_perm:[3,3,3,3] row_mask:0xf bank_mask:0xf
    v_mov_b32_dpp v63, v48 quad_perm:[0,0,0,0] row_mask:0xf bank_mask:0xf
    v_add_f32_dpp v63, v49, v63 quad_perm:[1,1,1,1] row_mask:0xf bank_mask:0xf
    v_add_f32_dpp v63, v50, v63 quad_perm:[2,2,2,2] row_mask:0xf bank_mask:0xf
    v_add_f32_dpp v63, v51, v63 quad_perm:[3,3,3,3] row_mask:0xf bank_mask:0xf
    v_cvt_pk_bf16_f32 v52, v60, v61
    v_cvt_pk_bf16_f32 v53, v62, v63
    s_mov_b64 exec, s[44:45]
    ds_write_b64 v14, v[52:53] offset:25600
    s_mov_b64 exec, -1
    v_add_u32 v14, 64, v14
    v_mfma_f32_16x16x32_bf16 v[36:39], a[32:35], v[20:23], 0
    v_mfma_f32_16x16x32_bf16 v[36:39], a[36:39], v[24:27], v[36:39]
    v_mfma_f32_16x16x32_bf16 v[40:43], a[40:43], v[20:23], 0
    v_mfma_f32_16x16x32_bf16 v[40:43], a[44:47], v[24:27], v[40:43]
    v_mfma_f32_16x16x32_bf16 v[44:47], a[48:51], v[20:23], 0
    v_mfma_f32_16x16x32_bf16 v[44:47], a[52:55], v[24:27], v[44:47]
    v_mfma_f32_16x16x32_bf16 v[48:51], a[56:59], v[20:23], 0
    v_mfma_f32_16x16x32_bf16 v[48:51], a[60:63], v[24:27], v[48:51]
    s_nop 1
    v_mov_b32_dpp v60, v36 quad_perm:[0,0,0,0] row_mask:0xf bank_mask:0xf
    v_add_f32_dpp v60, v37, v60 quad_perm:[1,1,1,1] row_mask:0xf bank_mask:0xf
    v_add_f32_dpp v60, v38, v60 quad_perm:[2,2,2,2] row_mask:0xf bank_mask:0xf
    v_add_f32_dpp v60, v39, v60 quad_perm:[3,3,3,3] row_mask:0xf bank_mask:0xf
    v_mov_b32_dpp v61, v40 quad_perm:[0,0,0,0] row_mask:0xf bank_mask:0xf
    v_add_f32_dpp v61, v41, v61 quad_perm:[1,1,1,1] row_mask:0xf bank_mask:0xf
    v_add_f32_dpp v61, v42, v61 quad_perm:[2,2,2,2] row_mask:0xf bank_mask:0xf
    v_add_f32_dpp v61, v43, v61 quad_perm:[3,3,3,3] row_mask:0xf bank_mask:0xf
    v_mov_b32_dpp v62, v44 quad_perm:[0,0,0,0] row_mask:0xf bank_mask:0xf
    v_add_f32_dpp v62, v45, v62 quad_perm:[1,1,1,1] row_mask:0xf bank_mask:0xf
    v_add_f32_dpp v62, v46, v62 quad_perm:[2,2,2,2] row_mask:0xf bank_mask:0xf
    v_add_f32_dpp v62, v47, v62 quad_perm:[3,3,3,3] row_mask:0xf bank_mask:0xf
    v_mov_b32_dpp v63, v48 quad_perm:[0,0,0,0] row_mask:0xf bank_mask:0xf
    v_add_f32_dpp v63, v49, v63 quad_perm:[1,1,1,1] row_mask:0xf bank_mask:0xf
    v_add_f32_dpp v63, v50, v63 quad_perm:[2,2,2,2] row_mask:0xf bank_mask:0xf
    v_add_f32_dpp v63, v51, v63 quad_perm:[3,3,3,3] row_mask:0xf bank_mask:0xf
    v_cvt_pk_bf16_f32 v52, v60, v61
    v_cvt_pk_bf16_f32 v53, v62, v63
    s_mov_b64 exec, s[44:45]
    ds_write_b64 v14, v[52:53] offset:25600
    s_mov_b64 exec, -1
    v_add_u32 v14, 64, v14
    v_mfma_f32_16x16x32_bf16 v[36:39], a[64:67], v[20:23], 0
    v_mfma_f32_16x16x32_bf16 v[36:39], a[68:71], v[24:27], v[36:39]
    v_mfma_f32_16x16x32_bf16 v[40:43], a[72:75], v[20:23], 0
    v_mfma_f32_16x16x32_bf16 v[40:43], a[76:79], v[24:27], v[40:43]
    v_mfma_f32_16x16x32_bf16 v[44:47], a[80:83], v[20:23], 0
    v_mfma_f32_16x16x32_bf16 v[44:47], a[84:87], v[24:27], v[44:47]
    v_mfma_f32_16x16x32_bf16 v[48:51], a[88:91], v[20:23], 0
    v_mfma_f32_16x16x32_bf16 v[48:51], a[92:95], v[24:27], v[48:51]
    s_nop 1
    v_mov_b32_dpp v60, v36 quad_perm:[0,0,0,0] row_mask:0xf bank_mask:0xf
    v_add_f32_dpp v60, v37, v60 quad_perm:[1,1,1,1] row_mask:0xf bank_mask:0xf
    v_add_f32_dpp v60, v38, v60 quad_perm:[2,2,2,2] row_mask:0xf bank_mask:0xf
    v_add_f32_dpp v60, v39, v60 quad_perm:[3,3,3,3] row_mask:0xf bank_mask:0xf
    v_mov_b32_dpp v61, v40 quad_perm:[0,0,0,0] row_mask:0xf bank_mask:0xf
    v_add_f32_dpp v61, v41, v61 quad_perm:[1,1,1,1] row_mask:0xf bank_mask:0xf
    v_add_f32_dpp v61, v42, v61 quad_perm:[2,2,2,2] row_mask:0xf bank_mask:0xf
    v_add_f32_dpp v61, v43, v61 quad_perm:[3,3,3,3] row_mask:0xf bank_mask:0xf
    v_mov_b32_dpp v62, v44 quad_perm:[0,0,0,0] row_mask:0xf bank_mask:0xf
    v_add_f32_dpp v62, v45, v62 quad_perm:[1,1,1,1] row_mask:0xf bank_mask:0xf
    v_add_f32_dpp v62, v46, v62 quad_perm:[2,2,2,2] row_mask:0xf bank_mask:0xf
    v_add_f32_dpp v62, v47, v62 quad_perm:[3,3,3,3] row_mask:0xf bank_mask:0xf
    v_mov_b32_dpp v63, v48 quad_perm:[0,0,0,0] row_mask:0xf bank_mask:0xf
    v_add_f32_dpp v63, v49, v63 quad_perm:[1,1,1,1] row_mask:0xf bank_mask:0xf
    v_add_f32_dpp v63, v50, v63 quad_perm:[2,2,2,2] row_mask:0xf bank_mask:0xf
    v_add_f32_dpp v63, v51, v63 quad_perm:[3,3,3,3] row_mask:0xf bank_mask:0xf
    v_cvt_pk_bf16_f32 v52, v60, v61
    v_cvt_pk_bf16_f32 v53, v62, v63
    s_mov_b64 exec, s[44:45]
    ds_write_b64 v14, v[52:53] offset:25600
    s_mov_b64 exec, -1
    v_add_u32 v14, 64, v14
    v_mfma_f32_16x16x32_bf16 v[36:39], a[96:99], v[20:23], 0
    v_mfma_f32_16x16x32_bf16 v[36:39], a[100:103], v[24:27], v[36:39]
    v_mfma_f32_16x16x32_bf16 v[40:43], a[104:107], v[20:23], 0
    v_mfma_f32_16x16x32_bf16 v[40:43], a[108:111], v[24:27], v[40:43]
    v_mfma_f32_16x16x32_bf16 v[44:47], a[112:115], v[20:23], 0
    v_mfma_f32_16x16x32_bf16 v[44:47], a[116:119], v[24:27], v[44:47]
    v_mfma_f32_16x16x32_bf16 v[48:51], a[120:123], v[20:23], 0
    v_mfma_f32_16x16x32_bf16 v[48:51], a[124:127], v[24:27], v[48:51]
    s_nop 1
    v_mov_b32_dpp v60, v36 quad_perm:[0,0,0,0] row_mask:0xf bank_mask:0xf
    v_add_f32_dpp v60, v37, v60 quad_perm:[1,1,1,1] row_mask:0xf bank_mask:0xf
    v_add_f32_dpp v60, v38, v60 quad_perm:[2,2,2,2] row_mask:0xf bank_mask:0xf
    v_add_f32_dpp v60, v39, v60 quad_perm:[3,3,3,3] row_mask:0xf bank_mask:0xf
    v_mov_b32_dpp v61, v40 quad_perm:[0,0,0,0] row_mask:0xf bank_mask:0xf
    v_add_f32_dpp v61, v41, v61 quad_perm:[1,1,1,1] row_mask:0xf bank_mask:0xf
    v_add_f32_dpp v61, v42, v61 quad_perm:[2,2,2,2] row_mask:0xf bank_mask:0xf
    v_add_f32_dpp v61, v43, v61 quad_perm:[3,3,3,3] row_mask:0xf bank_mask:0xf
    v_mov_b32_dpp v62, v44 quad_perm:[0,0,0,0] row_mask:0xf bank_mask:0xf
    v_add_f32_dpp v62, v45, v62 quad_perm:[1,1,1,1] row_mask:0xf bank_mask:0xf
    v_add_f32_dpp v62, v46, v62 quad_perm:[2,2,2,2] row_mask:0xf bank_mask:0xf
    v_add_f32_dpp v62, v47, v62 quad_perm:[3,3,3,3] row_mask:0xf bank_mask:0xf
    v_mov_b32_dpp v63, v48 quad_perm:[0,0,0,0] row_mask:0xf bank_mask:0xf
    v_add_f32_dpp v63, v49, v63 quad_perm:[1,1,1,1] row_mask:0xf bank_mask:0xf
    v_add_f32_dpp v63, v50, v63 quad_perm:[2,2,2,2] row_mask:0xf bank_mask:0xf
    v_add_f32_dpp v63, v51, v63 quad_perm:[3,3,3,3] row_mask:0xf bank_mask:0xf
    v_cvt_pk_bf16_f32 v52, v60, v61
    v_cvt_pk_bf16_f32 v53, v62, v63
    s_mov_b64 exec, s[44:45]
    ds_write_b64 v14, v[52:53] offset:25600
    s_mov_b64 exec, -1
    v_add_u32 v14, 64, v14
    v_mfma_f32_16x16x32_bf16 v[36:39], a[128:131], v[20:23], 0
    v_mfma_f32_16x16x32_bf16 v[36:39], a[132:135], v[24:27], v[36:39]
    v_mfma_f32_16x16x32_bf16 v[40:43], a[136:139], v[20:23], 0
    v_mfma_f32_16x16x32_bf16 v[40:43], a[140:143], v[24:27], v[40:43]
    v_mfma_f32_16x16x32_bf16 v[44:47], a[144:147], v[20:23], 0
    v_mfma_f32_16x16x32_bf16 v[44:47], a[148:151], v[24:27], v[44:47]
    v_mfma_f32_16x16x32_bf16 v[48:51], a[152:155], v[20:23], 0
    v_mfma_f32_16x16x32_bf16 v[48:51], a[156:159], v[24:27], v[48:51]
    s_nop 1
    v_mov_b32_dpp v60, v36 quad_perm:[0,0,0,0] row_mask:0xf bank_mask:0xf
    v_add_f32_dpp v60, v37, v60 quad_perm:[1,1,1,1] row_mask:0xf bank_mask:0xf
    v_add_f32_dpp v60, v38, v60 quad_perm:[2,2,2,2] row_mask:0xf bank_mask:0xf
    v_add_f32_dpp v60, v39, v60 quad_perm:[3,3,3,3] row_mask:0xf bank_mask:0xf
    v_mov_b32_dpp v61, v40 quad_perm:[0,0,0,0] row_mask:0xf bank_mask:0xf
    v_add_f32_dpp v61, v41, v61 quad_perm:[1,1,1,1] row_mask:0xf bank_mask:0xf
    v_add_f32_dpp v61, v42, v61 quad_perm:[2,2,2,2] row_mask:0xf bank_mask:0xf
    v_add_f32_dpp v61, v43, v61 quad_perm:[3,3,3,3] row_mask:0xf bank_mask:0xf
    v_mov_b32_dpp v62, v44 quad_perm:[0,0,0,0] row_mask:0xf bank_mask:0xf
    v_add_f32_dpp v62, v45, v62 quad_perm:[1,1,1,1] row_mask:0xf bank_mask:0xf
    v_add_f32_dpp v62, v46, v62 quad_perm:[2,2,2,2] row_mask:0xf bank_mask:0xf
    v_add_f32_dpp v62, v47, v62 quad_perm:[3,3,3,3] row_mask:0xf bank_mask:0xf
    v_mov_b32_dpp v63, v48 quad_perm:[0,0,0,0] row_mask:0xf bank_mask:0xf
    v_add_f32_dpp v63, v49, v63 quad_perm:[1,1,1,1] row_mask:0xf bank_mask:0xf
    v_add_f32_dpp v63, v50, v63 quad_perm:[2,2,2,2] row_mask:0xf bank_mask:0xf
    v_add_f32_dpp v63, v51, v63 quad_perm:[3,3,3,3] row_mask:0xf bank_mask:0xf
    v_cvt_pk_bf16_f32 v52, v60, v61
    v_cvt_pk_bf16_f32 v53, v62, v63
    s_mov_b64 exec, s[44:45]
    ds_write_b64 v14, v[52:53] offset:25600
    s_mov_b64 exec, -1
    v_add_u32 v14, 64, v14
    s_waitcnt vmcnt(16)
    v_mfma_f32_16x16x32_bf16 v[36:39], a[160:163], v[20:23], 0
    v_mfma_f32_16x16x32_bf16 v[36:39], a[164:167], v[24:27], v[36:39]
    v_mfma_f32_16x16x32_bf16 v[40:43], a[168:171], v[20:23], 0
    v_mfma_f32_16x16x32_bf16 v[40:43], a[172:175], v[24:27], v[40:43]
    v_mfma_f32_16x16x32_bf16 v[44:47], a[176:179], v[20:23], 0
    v_mfma_f32_16x16x32_bf16 v[44:47], a[180:183], v[24:27], v[44:47]
    v_mfma_f32_16x16x32_bf16 v[48:51], a[184:187], v[20:23], 0
    v_mfma_f32_16x16x32_bf16 v[48:51], a[188:191], v[24:27], v[48:51]
    s_nop 1
    v_mov_b32_dpp v60, v36 quad_perm:[0,0,0,0] row_mask:0xf bank_mask:0xf
    v_add_f32_dpp v60, v37, v60 quad_perm:[1,1,1,1] row_mask:0xf bank_mask:0xf
    v_add_f32_dpp v60, v38, v60 quad_perm:[2,2,2,2] row_mask:0xf bank_mask:0xf
    v_add_f32_dpp v60, v39, v60 quad_perm:[3,3,3,3] row_mask:0xf bank_mask:0xf
    v_mov_b32_dpp v61, v40 quad_perm:[0,0,0,0] row_mask:0xf bank_mask:0xf
    v_add_f32_dpp v61, v41, v61 quad_perm:[1,1,1,1] row_mask:0xf bank_mask:0xf
    v_add_f32_dpp v61, v42, v61 quad_perm:[2,2,2,2] row_mask:0xf bank_mask:0xf
    v_add_f32_dpp v61, v43, v61 quad_perm:[3,3,3,3] row_mask:0xf bank_mask:0xf
    v_mov_b32_dpp v62, v44 quad_perm:[0,0,0,0] row_mask:0xf bank_mask:0xf
    v_add_f32_dpp v62, v45, v62 quad_perm:[1,1,1,1] row_mask:0xf bank_mask:0xf
    v_add_f32_dpp v62, v46, v62 quad_perm:[2,2,2,2] row_mask:0xf bank_mask:0xf
    v_add_f32_dpp v62, v47, v62 quad_perm:[3,3,3,3] row_mask:0xf bank_mask:0xf
    v_mov_b32_dpp v63, v48 quad_perm:[0,0,0,0] row_mask:0xf bank_mask:0xf
    v_add_f32_dpp v63, v49, v63 quad_perm:[1,1,1,1] row_mask:0xf bank_mask:0xf
    v_add_f32_dpp v63, v50, v63 quad_perm:[2,2,2,2] row_mask:0xf bank_mask:0xf
    v_add_f32_dpp v63, v51, v63 quad_perm:[3,3,3,3] row_mask:0xf bank_mask:0xf
    v_cvt_pk_bf16_f32 v52, v60, v61
    v_cvt_pk_bf16_f32 v53, v62, v63
    s_mov_b64 exec, s[44:45]
    ds_write_b64 v14, v[52:53] offset:25600
    s_mov_b64 exec, -1
    v_add_u32 v14, 64, v14
    s_waitcnt vmcnt(8)
    v_mfma_f32_16x16x32_bf16 v[36:39], a[192:195], v[20:23], 0
    v_mfma_f32_16x16x32_bf16 v[36:39], a[196:199], v[24:27], v[36:39]
    v_mfma_f32_16x16x32_bf16 v[40:43], a[200:203], v[20:23], 0
    v_mfma_f32_16x16x32_bf16 v[40:43], a[204:207], v[24:27], v[40:43]
    v_mfma_f32_16x16x32_bf16 v[44:47], a[208:211], v[20:23], 0
    v_mfma_f32_16x16x32_bf16 v[44:47], a[212:215], v[24:27], v[44:47]
    v_mfma_f32_16x16x32_bf16 v[48:51], a[216:219], v[20:23], 0
    v_mfma_f32_16x16x32_bf16 v[48:51], a[220:223], v[24:27], v[48:51]
    s_nop 1
    v_mov_b32_dpp v60, v36 quad_perm:[0,0,0,0] row_mask:0xf bank_mask:0xf
    v_add_f32_dpp v60, v37, v60 quad_perm:[1,1,1,1] row_mask:0xf bank_mask:0xf
    v_add_f32_dpp v60, v38, v60 quad_perm:[2,2,2,2] row_mask:0xf bank_mask:0xf
    v_add_f32_dpp v60, v39, v60 quad_perm:[3,3,3,3] row_mask:0xf bank_mask:0xf
    v_mov_b32_dpp v61, v40 quad_perm:[0,0,0,0] row_mask:0xf bank_mask:0xf
    v_add_f32_dpp v61, v41, v61 quad_perm:[1,1,1,1] row_mask:0xf bank_mask:0xf
    v_add_f32_dpp v61, v42, v61 quad_perm:[2,2,2,2] row_mask:0xf bank_mask:0xf
    v_add_f32_dpp v61, v43, v61 quad_perm:[3,3,3,3] row_mask:0xf bank_mask:0xf
    v_mov_b32_dpp v62, v44 quad_perm:[0,0,0,0] row_mask:0xf bank_mask:0xf
    v_add_f32_dpp v62, v45, v62 quad_perm:[1,1,1,1] row_mask:0xf bank_mask:0xf
    v_add_f32_dpp v62, v46, v62 quad_perm:[2,2,2,2] row_mask:0xf bank_mask:0xf
    v_add_f32_dpp v62, v47, v62 quad_perm:[3,3,3,3] row_mask:0xf bank_mask:0xf
    v_mov_b32_dpp v63, v48 quad_perm:[0,0,0,0] row_mask:0xf bank_mask:0xf
    v_add_f32_dpp v63, v49, v63 quad_perm:[1,1,1,1] row_mask:0xf bank_mask:0xf
    v_add_f32_dpp v63, v50, v63 quad_perm:[2,2,2,2] row_mask:0xf bank_mask:0xf
    v_add_f32_dpp v63, v51, v63 quad_perm:[3,3,3,3] row_mask:0xf bank_mask:0xf
    v_cvt_pk_bf16_f32 v52, v60, v61
    v_cvt_pk_bf16_f32 v53, v62, v63
    s_mov_b64 exec, s[44:45]
    ds_write_b64 v14, v[52:53] offset:25600
    s_mov_b64 exec, -1
    v_add_u32 v14, 64, v14
    s_cmp_lg_u32 s3, 0
    s_nop 0
    s_cbranch_scc1 L_ecode_kernel_ksubP
    v_lshlrev_b32 v5, 3, v0
    ds_read_b64 v[108:109], v5 offset:22272
    ds_read_b64 v[110:111], v5 offset:22784
    ds_read_b64 v[112:113], v5 offset:23296
    ds_read_b64 v[114:115], v5 offset:23808
    s_waitcnt lgkmcnt(0)
    v_add_f32 v108, v108, v110
    v_add_f32 v109, v109, v111
    v_add_f32 v112, v112, v114
    v_add_f32 v113, v113, v115
    v_add_f32 v116, v108, v112
    v_add_f32 v117, v109, v113
    v_lshrrev_b32 v7, 5, v0
    v_mul_u32_u24 v7, 7168, v7
    v_and_b32 v8, 31, v0
    v_lshl_add_u32 v7, v8, 3, v7
    s_lshl_b32 s7, s71, 1
    s_bfe_u32 s73, s2, 0x10002
    s_add_u32 s7, s7, s73
    s_mul_i32 s7, s7, 14336
    s_lshl_b32 s73, s72, 8
    s_add_u32 s7, s7, s73
    s_add_u32 s7, s7, 2359296
    s_cmp_ge_u32 s2, 224
    s_cselect_b32 s7, 0x7fff0000, s7
    v_mov_b32 v124, -1
    v_mov_b32 v125, -1
    v_mov_b32 v126, -1
    v_mov_b32 v127, -1
    v_mov_b32 v123, 0
    v_add_u32 v11, 0x1000, v9
    buffer_store_dwordx2 v[116:117], v7, s[48:51], s7 offen sc1
    buffer_store_dwordx4 v[124:127], v9, s[48:51], s68 offen offset:0 sc1
    buffer_store_dwordx4 v[124:127], v9, s[48:51], s68 offen offset:1024 sc1
    buffer_store_dwordx4 v[124:127], v9, s[48:51], s68 offen offset:2048 sc1
    buffer_store_dwordx4 v[124:127], v9, s[48:51], s68 offen offset:3072 sc1
    buffer_store_dwordx4 v[124:127], v11, s[48:51], s68 offen offset:0 sc1
    buffer_store_dwordx4 v[124:127], v11, s[48:51], s68 offen offset:1024 sc1
    buffer_store_dwordx4 v[124:127], v11, s[48:51], s68 offen offset:2048 sc1
    s_add_u32 s7, s68, 7168
    s_mov_b64 exec, 1
    buffer_store_dword v123, off, s[48:51], s7 sc1
    s_mov_b64 exec, -1
    s_branch L_ecode_kernel_ksubP
L_ecode_kernel_kloop:
    s_cmp_eq_u32 s11, s98
    s_cbranch_scc1 L_ecode_kernel_ksvc
L_ecode_kernel_kloop2:
    s_and_b32 s100, s6, 4278583295
    s_and_b32 s101, s6, 131072
    s_lshl_b32 s101, s101, 4
    s_or_b32 s100, s100, s101
    s_and_b32 s101, s6, 524288
    s_lshr_b32 s101, s101, 2
    s_or_b32 s100, s100, s101
    s_and_b32 s101, s6, 1048576
    s_lshl_b32 s101, s101, 3
    s_or_b32 s100, s100, s101
    s_and_b32 s101, s6, 2097152
    s_lshl_b32 s101, s101, 1
    s_or_b32 s100, s100, s101
    s_and_b32 s101, s6, 12582912
    s_lshr_b32 s101, s101, 3
    s_or_b32 s100, s100, s101
    s_waitcnt vmcnt(6)
    v_mfma_f32_16x16x32_bf16 v[36:39], v[128:131], v[20:23], 0
    buffer_load_dwordx4 v[128:131], v1, s[40:43], s100 offen offset:0 nt
    s_waitcnt vmcnt(6)
    v_mfma_f32_16x16x32_bf16 v[36:39], v[132:135], v[24:27], v[36:39]
    buffer_load_dwordx4 v[132:135], v1, s[40:43], s100 offen offset:256 nt
    s_waitcnt vmcnt(6)
    v_mfma_f32_16x16x32_bf16 v[40:43], v[136:139], v[20:23], 0
    buffer_load_dwordx4 v[136:139], v1, s[40:43], s100 offen offset:2048 nt
    s_waitcnt vmcnt(6)
    v_mfma_f32_16x16x32_bf16 v[40:43], v[140:143], v[24:27], v[40:43]
    buffer_load_dwordx4 v[140:143], v1, s[40:43], s100 offen offset:2304 nt
    s_waitcnt vmcnt(6)
    v_mfma_f32_16x16x32_bf16 v[44:47], v[144:147], v[20:23], 0
    buffer_load_dwordx4 v[144:147], v2, s[40:43], s100 offen offset:0 nt
    s_waitcnt vmcnt(6)
    v_mfma_f32_16x16x32_bf16 v[44:47], v[148:151], v[24:27], v[44:47]
    buffer_load_dwordx4 v[148:151], v2, s[40:43], s100 offen offset:256 nt
    s_waitcnt vmcnt(6)
    v_mfma_f32_16x16x32_bf16 v[48:51], v[152:155], v[20:23], 0
    buffer_load_dwordx4 v[152:155], v2, s[40:43], s100 offen offset:2048 nt
    s_waitcnt vmcnt(6)
    v_mfma_f32_16x16x32_bf16 v[48:51], v[156:159], v[24:27], v[48:51]
    buffer_load_dwordx4 v[156:159], v2, s[40:43], s100 offen offset:2304 nt
    v_mov_b32_dpp v60, v36 quad_perm:[0,0,0,0] row_mask:0xf bank_mask:0xf
    v_add_f32_dpp v60, v37, v60 quad_perm:[1,1,1,1] row_mask:0xf bank_mask:0xf
    v_add_f32_dpp v60, v38, v60 quad_perm:[2,2,2,2] row_mask:0xf bank_mask:0xf
    v_add_f32_dpp v60, v39, v60 quad_perm:[3,3,3,3] row_mask:0xf bank_mask:0xf
    v_mov_b32_dpp v61, v40 quad_perm:[0,0,0,0] row_mask:0xf bank_mask:0xf
    v_add_f32_dpp v61, v41, v61 quad_perm:[1,1,1,1] row_mask:0xf bank_mask:0xf
    v_add_f32_dpp v61, v42, v61 quad_perm:[2,2,2,2] row_mask:0xf bank_mask:0xf
    v_add_f32_dpp v61, v43, v61 quad_perm:[3,3,3,3] row_mask:0xf bank_mask:0xf
    v_mov_b32_dpp v62, v44 quad_perm:[0,0,0,0] row_mask:0xf bank_mask:0xf
    v_add_f32_dpp v62, v45, v62 quad_perm:[1,1,1,1] row_mask:0xf bank_mask:0xf
    v_add_f32_dpp v62, v46, v62 quad_perm:[2,2,2,2] row_mask:0xf bank_mask:0xf
    v_add_f32_dpp v62, v47, v62 quad_perm:[3,3,3,3] row_mask:0xf bank_mask:0xf
    v_mov_b32_dpp v63, v48 quad_perm:[0,0,0,0] row_mask:0xf bank_mask:0xf
    v_add_f32_dpp v63, v49, v63 quad_perm:[1,1,1,1] row_mask:0xf bank_mask:0xf
    v_add_f32_dpp v63, v50, v63 quad_perm:[2,2,2,2] row_mask:0xf bank_mask:0xf
    v_add_f32_dpp v63, v51, v63 quad_perm:[3,3,3,3] row_mask:0xf bank_mask:0xf
    v_cvt_pk_bf16_f32 v52, v60, v61
    v_cvt_pk_bf16_f32 v53, v62, v63
    s_mov_b64 exec, s[44:45]
    ds_write_b64 v14, v[52:53] offset:25600
    s_mov_b64 exec, -1
    v_add_u32 v14, 64, v14
    s_add_u32 s6, s6, 0x80000
    s_add_u32 s11, s11, 1
L_ecode_kernel_ksubP:
    s_cmp_lt_u32 s11, 25
    s_cbranch_scc1 L_ecode_kernel_kloop
    s_mov_b32 s11, 0
    s_mov_b32 s98, 20
    v_mov_b32 v5, 0xff7fffff
    v_mov_b32 v6, 0
    s_lshl_b32 s75, s5, 24
    s_lshl_b32 s15, s4, 2
    s_add_u32 s15, s15, s3
    s_lshl_b32 s15, s15, 13
    s_add_u32 s15, s15, s75
    s_add_u32 s7, s3, s4
    s_and_b32 s7, s7, 3
    s_lshl_b32 s7, s7, 13
    s_add_u32 s75, s75, s7
    s_add_u32 s75, s75, 0
    s_mov_b32 s76, -1
    s_mul_i32 s47, s5, 36864
    s_add_u32 s47, s47, 3145728
    s_lshl_b32 s7, s3, 11
    s_add_u32 s7, s7, 576
    v_add_u32 v14, s7, v15
    v_mov_b32 v28, 0
    v_mov_b32 v29, 0
    v_mov_b32 v30, 0
    v_mov_b32 v31, 0
    v_mov_b32 v32, 0
    v_mov_b32 v33, 0
    v_mov_b32 v34, 0
    v_mov_b32 v35, 0
    s_mov_b32 s26, 3670016
    s_mov_b32 s27, 0x20000
    s_mov_b32 s60, s34
    s_mov_b32 s61, s35
    s_mov_b32 s34, 1605632
    s_mov_b32 s35, 0x20000
    v_lshrrev_b32 v7, 4, v0
    v_and_b32 v10, 15, v0
    v_lshlrev_b32 v10, 4, v10
    v_mul_u32_u24 v11, 7168, v7
    v_add_u32 v24, v11, v10
    v_mul_u32_u24 v11, 3584, v7
    v_add_u32 v25, v11, v10
    s_mul_i32 s28, s69, 28672
    s_lshl_b32 s7, s3, 8
    s_add_u32 s28, s28, s7
    s_add_u32 s29, s28, 3584
    s_mul_i32 s30, s69, 12544
    s_add_u32 s30, s30, s7
    s_cmp_eq_u32 s3, 3
    s_cselect_b32 s26, 0, s26
    s_cselect_b32 s34, 0, s34
    s_cmp_eq_u32 s3, 2
    s_cselect_b32 s31, 0, 0x7fff0000
L_ecode_kernel_vloop:
    s_cmp_eq_u32 s11, s98
    s_cbranch_scc1 L_ecode_kernel_vsvc
L_ecode_kernel_vloop2:
    ds_read_b64 v[40:41], v14 offset:25600
    v_add_u32 v14, 64, v14
    s_waitcnt vmcnt(8)
    v_readfirstlane_b32 s77, v20
    s_add_u32 s79, s11, 1
    s_lshl_b32 s78, s77, 15
    s_add_u32 s78, s78, s75
    s_cmp_ge_u32 s11, 22
    s_cselect_b32 s14, s78, s6
    s_cselect_b32 s77, s77, 0
    s_cselect_b32 s78, 144, 1
    s_cmp_ge_u32 s77, s78
    s_cselect_b32 s42, 0, s42
    s_cselect_b32 s66, 0, s66
    s_cselect_b32 s79, s79, -1
    s_min_u32 s76, s76, s79
    s_waitcnt lgkmcnt(0)
    s_cmp_lt_u32 s11, 23
    s_cbranch_scc1 L_ecode_kernel_vs0
    v_mov_b32 v40, v64
    v_mov_b32 v41, v65
L_ecode_kernel_vs0:
    s_cmp_eq_u32 s42, 0
    s_nop 0
    s_cbranch_scc1 L_ecode_kernel_vlast
    s_bfe_u32 s7, s14, 0x6000d
    s_mul_i32 s7, s7, 576
    s_bfe_u32 s46, s14, 0x50013
    s_lshl_b32 s46, s46, 6
    s_add_u32 s7, s7, s46
    s_add_u32 s7, s7, s47
    s_cmp_ge_u32 s11, 22
    s_cselect_b32 s7, s7, 0x7fff0000
    s_cmp_eq_u32 s42, 0
    s_cselect_b32 s7, 0x7fff0000, s7
    v_mov_b32 v20, 1
    s_mov_b64 exec, 1
    buffer_atomic_add v20, off, s[64:67], 0 sc0
    s_mov_b64 exec, -1
    s_and_b32 s100, s14, 4278583295
    s_and_b32 s101, s14, 131072
    s_lshl_b32 s101, s101, 4
    s_or_b32 s100, s100, s101
    s_and_b32 s101, s14, 524288
    s_lshr_b32 s101, s101, 2
    s_or_b32 s100, s100, s101
    s_and_b32 s101, s14, 1048576
    s_lshl_b32 s101, s101, 3
    s_or_b32 s100, s100, s101
    s_and_b32 s101, s14, 2097152
    s_lshl_b32 s101, s101, 1
    s_or_b32 s100, s100, s101
    s_and_b32 s101, s14, 12582912
    s_lshr_b32 s101, s101, 3
    s_or_b32 s100, s100, s101
    buffer_load_dwordx2 v[64:65], v15, s[48:51], s7 offen sc1
    v_lshlrev_b32 v60, 16, v40
    v_and_b32 v61, 0xffff0000, v40
    v_lshlrev_b32 v62, 16, v41
    v_and_b32 v63, 0xffff0000, v41
    v_max3_f32 v7, v60, v61, v62
    v_max3_f32 v7, v7, v63, v5
    v_mov_b32 v8, v7
    s_nop 1
    v_permlane16_swap_b32 v8, v7
    v_max_f32 v7, v7, v8
    v_mov_b32 v8, v7
    s_nop 1
    v_permlane32_swap_b32 v8, v7
    v_max_f32 v7, v7, v8
    v_sub_f32 v8, v5, v7
    v_mul_f32 v8, s10, v8
    v_exp_f32 v8, v8
    v_mov_b32 v5, v7
    v_mul_f32 v9, s10, v7
    v_mov_b32_dpp v10, v8 row_ror:8 row_mask:0xf bank_mask:0xf
    v_mul_f32 v6, v6, v8
    v_cndmask_b32 v10, v8, v10, s[8:9]
    v_mul_f32 v28, v28, v10
    v_mul_f32 v29, v29, v10
    v_mul_f32 v30, v30, v10
    v_mul_f32 v31, v31, v10
    v_mul_f32 v32, v32, v10
    v_mul_f32 v33, v33, v10
    v_mul_f32 v34, v34, v10
    v_mul_f32 v35, v35, v10
    v_fma_f32 v60, v60, s10, -v9
    v_fma_f32 v61, v61, s10, -v9
    v_fma_f32 v62, v62, s10, -v9
    v_fma_f32 v63, v63, s10, -v9
    v_exp_f32 v60, v60
    v_exp_f32 v61, v61
    v_exp_f32 v62, v62
    v_exp_f32 v63, v63
    v_cvt_pk_bf16_f32 v11, v60, v60
    v_add_f32 v6, v6, v60
    v_and_b32 v52, v11, v16
    v_and_b32 v53, v11, v17
    v_and_b32 v54, v11, v18
    v_and_b32 v55, v11, v19
    s_waitcnt vmcnt(7)
    s_nop 0
    v_mfma_f32_16x16x32_bf16 v[28:31], v[52:55], v[128:131], v[28:31]
    buffer_load_dwordx4 v[128:131], v1, s[40:43], s100 offen offset:0 nt
    s_waitcnt vmcnt(7)
    v_mfma_f32_16x16x32_bf16 v[32:35], v[52:55], v[132:135], v[32:35]
    buffer_load_dwordx4 v[132:135], v1, s[40:43], s100 offen offset:256 nt
    v_cvt_pk_bf16_f32 v11, v61, v61
    v_add_f32 v6, v6, v61
    v_and_b32 v56, v11, v16
    v_and_b32 v57, v11, v17
    v_and_b32 v58, v11, v18
    v_and_b32 v59, v11, v19
    s_waitcnt vmcnt(7)
    s_nop 0
    v_mfma_f32_16x16x32_bf16 v[28:31], v[56:59], v[136:139], v[28:31]
    buffer_load_dwordx4 v[136:139], v1, s[40:43], s100 offen offset:2048 nt
    s_waitcnt vmcnt(7)
    v_mfma_f32_16x16x32_bf16 v[32:35], v[56:59], v[140:143], v[32:35]
    buffer_load_dwordx4 v[140:143], v1, s[40:43], s100 offen offset:2304 nt
    v_cvt_pk_bf16_f32 v11, v62, v62
    v_add_f32 v6, v6, v62
    v_and_b32 v52, v11, v16
    v_and_b32 v53, v11, v17
    v_and_b32 v54, v11, v18
    v_and_b32 v55, v11, v19
    s_waitcnt vmcnt(7)
    s_nop 0
    v_mfma_f32_16x16x32_bf16 v[28:31], v[52:55], v[144:147], v[28:31]
    buffer_load_dwordx4 v[144:147], v2, s[40:43], s100 offen offset:0 nt
    s_waitcnt vmcnt(7)
    v_mfma_f32_16x16x32_bf16 v[32:35], v[52:55], v[148:151], v[32:35]
    buffer_load_dwordx4 v[148:151], v2, s[40:43], s100 offen offset:256 nt
    v_cvt_pk_bf16_f32 v11, v63, v63
    v_add_f32 v6, v6, v63
    v_and_b32 v56, v11, v16
    v_and_b32 v57, v11, v17
    v_and_b32 v58, v11, v18
    v_and_b32 v59, v11, v19
    s_waitcnt vmcnt(7)
    s_nop 0
    v_mfma_f32_16x16x32_bf16 v[28:31], v[56:59], v[152:155], v[28:31]
    buffer_load_dwordx4 v[152:155], v2, s[40:43], s100 offen offset:2048 nt
    s_waitcnt vmcnt(7)
    v_mfma_f32_16x16x32_bf16 v[32:35], v[56:59], v[156:159], v[32:35]
    buffer_load_dwordx4 v[156:159], v2, s[40:43], s100 offen offset:2304 nt
    s_add_u32 s6, s6, 0x80000
    s_add_u32 s11, s11, 1
    s_cmp_eq_u32 s11, 22
    s_cselect_b32 s6, s15, s6
    s_cmp_eq_u32 s11, s76
    s_nop 1
    s_cbranch_scc0 L_ecode_kernel_vloop
    s_branch L_ecode_kernel_sdone
L_ecode_kernel_vlast:
    buffer_load_dwordx4 a[192:195], v25, s[32:35], s30 offen offset:0 nt
    buffer_load_dwordx4 a[196:199], v25, s[32:35], s30 offen offset:896 nt
    buffer_load_dwordx4 a[200:203], v25, s[32:35], s30 offen offset:1792 nt
    buffer_load_dwordx4 a[204:207], v25, s[32:35], s30 offen offset:2688 nt
    buffer_load_dwordx4 a[128:131], v24, s[24:27], s28 offen offset:0 nt
    buffer_load_dwordx4 a[132:135], v24, s[24:27], s28 offen offset:896 nt
    buffer_load_dwordx4 a[136:139], v24, s[24:27], s28 offen offset:1792 nt
    buffer_load_dwordx4 a[140:143], v24, s[24:27], s28 offen offset:2688 nt
    buffer_load_dwordx4 a[144:147], v24, s[24:27], s29 offen offset:0 nt
    buffer_load_dwordx4 a[148:151], v24, s[24:27], s29 offen offset:896 nt
    buffer_load_dwordx4 a[152:155], v24, s[24:27], s29 offen offset:1792 nt
    buffer_load_dwordx4 a[156:159], v24, s[24:27], s29 offen offset:2688 nt
    s_add_u32 s28, s28, s31
    s_add_u32 s29, s29, s31
    s_add_u32 s30, s30, s31
    s_mov_b32 exec_lo, 0x00ff00ff
    s_mov_b32 exec_hi, 0x00ff00ff
    buffer_load_dwordx4 a[208:211], v25, s[32:35], s30 offen offset:256 nt
    buffer_load_dwordx4 a[212:215], v25, s[32:35], s30 offen offset:1152 nt
    buffer_load_dwordx4 a[216:219], v25, s[32:35], s30 offen offset:2048 nt
    buffer_load_dwordx4 a[220:223], v25, s[32:35], s30 offen offset:2944 nt
    buffer_load_dwordx4 a[160:163], v24, s[24:27], s28 offen offset:256 nt
    buffer_load_dwordx4 a[164:167], v24, s[24:27], s28 offen offset:1152 nt
    buffer_load_dwordx4 a[168:171], v24, s[24:27], s28 offen offset:2048 nt
    buffer_load_dwordx4 a[172:175], v24, s[24:27], s28 offen offset:2944 nt
    buffer_load_dwordx4 a[176:179], v24, s[24:27], s29 offen offset:256 nt
    buffer_load_dwordx4 a[180:183], v24, s[24:27], s29 offen offset:1152 nt
    buffer_load_dwordx4 a[184:187], v24, s[24:27], s29 offen offset:2048 nt
    buffer_load_dwordx4 a[188:191], v24, s[24:27], s29 offen offset:2944 nt
    s_mov_b64 exec, -1
    v_lshlrev_b32 v60, 16, v40
    v_and_b32 v61, 0xffff0000, v40
    v_lshlrev_b32 v62, 16, v41
    v_and_b32 v63, 0xffff0000, v41
    v_max3_f32 v7, v60, v61, v62
    v_max3_f32 v7, v7, v63, v5
    v_mov_b32 v8, v7
    s_nop 1
    v_permlane16_swap_b32 v8, v7
    v_max_f32 v7, v7, v8
    v_mov_b32 v8, v7
    s_nop 1
    v_permlane32_swap_b32 v8, v7
    v_max_f32 v7, v7, v8
    v_sub_f32 v8, v5, v7
    v_mul_f32 v8, s10, v8
    v_exp_f32 v8, v8
    v_mov_b32 v5, v7
    v_mul_f32 v9, s10, v7
    v_mov_b32_dpp v10, v8 row_ror:8 row_mask:0xf bank_mask:0xf
    v_mul_f32 v6, v6, v8
    v_cndmask_b32 v10, v8, v10, s[8:9]
    v_mul_f32 v28, v28, v10
    v_mul_f32 v29, v29, v10
    v_mul_f32 v30, v30, v10
    v_mul_f32 v31, v31, v10
    v_mul_f32 v32, v32, v10
    v_mul_f32 v33, v33, v10
    v_mul_f32 v34, v34, v10
    v_mul_f32 v35, v35, v10
    v_fma_f32 v60, v60, s10, -v9
    v_fma_f32 v61, v61, s10, -v9
    v_fma_f32 v62, v62, s10, -v9
    v_fma_f32 v63, v63, s10, -v9
    v_exp_f32 v60, v60
    v_exp_f32 v61, v61
    v_exp_f32 v62, v62
    v_exp_f32 v63, v63
    v_cvt_pk_bf16_f32 v11, v60, v60
    v_add_f32 v6, v6, v60
    v_and_b32 v52, v11, v16
    v_and_b32 v53, v11, v17
    v_and_b32 v54, v11, v18
    v_and_b32 v55, v11, v19
    s_waitcnt vmcnt(31)
    s_nop 0
    v_mfma_f32_16x16x32_bf16 v[28:31], v[52:55], v[128:131], v[28:31]
    s_waitcnt vmcnt(30)
    v_mfma_f32_16x16x32_bf16 v[32:35], v[52:55], v[132:135], v[32:35]
    v_cvt_pk_bf16_f32 v11, v61, v61
    v_add_f32 v6, v6, v61
    v_and_b32 v56, v11, v16
    v_and_b32 v57, v11, v17
    v_and_b32 v58, v11, v18
    v_and_b32 v59, v11, v19
    s_waitcnt vmcnt(29)
    s_nop 0
    v_mfma_f32_16x16x32_bf16 v[28:31], v[56:59], v[136:139], v[28:31]
    s_waitcnt vmcnt(28)
    v_mfma_f32_16x16x32_bf16 v[32:35], v[56:59], v[140:143], v[32:35]
    v_cvt_pk_bf16_f32 v11, v62, v62
    v_add_f32 v6, v6, v62
    v_and_b32 v52, v11, v16
    v_and_b32 v53, v11, v17
    v_and_b32 v54, v11, v18
    v_and_b32 v55, v11, v19
    s_waitcnt vmcnt(27)
    s_nop 0
    v_mfma_f32_16x16x32_bf16 v[28:31], v[52:55], v[144:147], v[28:31]
    s_waitcnt vmcnt(26)
    v_mfma_f32_16x16x32_bf16 v[32:35], v[52:55], v[148:151], v[32:35]
    v_cvt_pk_bf16_f32 v11, v63, v63
    v_add_f32 v6, v6, v63
    v_and_b32 v56, v11, v16
    v_and_b32 v57, v11, v17
    v_and_b32 v58, v11, v18
    v_and_b32 v59, v11, v19
    s_waitcnt vmcnt(25)
    s_nop 0
    v_mfma_f32_16x16x32_bf16 v[28:31], v[56:59], v[152:155], v[28:31]
    s_waitcnt vmcnt(24)
    v_mfma_f32_16x16x32_bf16 v[32:35], v[56:59], v[156:159], v[32:35]
    s_add_u32 s11, s11, 1
    s_nop 6
    s_branch L_ecode_kernel_sdone
L_ecode_kernel_ksvc:
    s_cmp_eq_u32 s11, 4
    s_cbranch_scc1 L_ecode_kernel_rdy
    s_cmp_eq_u32 s11, 24
    s_cbranch_scc1 L_ecode_kernel_kv
    s_cmp_eq_u32 s11, 1
    s_cbranch_scc1 L_ecode_kernel_svc2b
    s_mov_b32 s98, 4
    v_lshlrev_b32 v7, 4, v0
    s_lshl_b32 s7, s3, 11
    v_add_u32 v8, s7, v7
    ds_read_b128 v[96:99], v8 offset:25600
    ds_read_b128 v[100:103], v8 offset:26624
    s_lshl_b32 s7, s4, 4
    s_add_u32 s7, s7, s5
    s_lshl_b32 s7, s7, 2
    s_add_u32 s7, s7, s3
    s_mul_i32 s7, s7, 576
    s_add_u32 s7, s7, 3145728
    v_cmp_gt_u32 vcc, 36, v0
    v_cmp_gt_u32 s[46:47], 0, v0
    s_waitcnt lgkmcnt(0)
    s_mov_b64 exec, vcc
    buffer_store_dwordx4 v[96:99], v7, s[48:51], s7 offen sc1
    s_mov_b64 exec, -1
    s_nop 0
    s_branch L_ecode_kernel_kloop2
L_ecode_kernel_svc2b:
    s_mov_b32 s98, 2
    v_lshrrev_b32 v7, 4, v0
    s_lshl_b32 s74, s69, 3
    s_mul_i32 s72, s70, 896
    s_add_u32 s74, s74, s72
    v_and_b32 v11, 0, v0
    v_lshl_add_u32 v11, v11, 2, v7
    v_lshlrev_b32 v91, 1, v11
    buffer_load_ushort v90, v91, s[60:63], s74 offen
    s_mov_b32 s73, 0
    s_branch L_ecode_kernel_kloop2
L_ecode_kernel_rdy:
    s_mov_b32 s98, 24
    v_mov_b32 v7, s97
    s_lshl_b32 s7, s2, 2
    s_add_u32 s7, s7, s3
    s_lshl_b32 s7, s7, 2
    s_add_u32 s7, s7, 2475008
    s_waitcnt vmcnt(6)
    s_mov_b64 exec, 1
    buffer_store_dword v7, off, s[48:51], s7 sc1
    s_mov_b64 exec, -1
    s_branch L_ecode_kernel_kloop2
L_ecode_kernel_kv:
    s_mov_b32 s98, -1
    s_mov_b32 s40, s20
    s_mov_b32 s41, s21
    s_add_u32 s6, s99, 4718592
    v_mov_b32 v1, v3
    v_mov_b32 v2, v4
    s_nop 1
    s_branch L_ecode_kernel_kloop2
L_ecode_kernel_vsvc:
    s_cmp_eq_u32 s11, 21
    s_cbranch_scc1 L_ecode_kernel_svc4
    s_cmp_eq_u32 s11, 23
    s_cbranch_scc1 L_ecode_kernel_switch
    s_mov_b32 s98, 21
    v_lshlrev_b32 v13, 4, v0
    s_mov_b32 s7, 2475008
    buffer_load_dwordx4 v[96:99], v13, s[48:51], s7 offen offset:0 sc1
    buffer_load_dwordx4 v[100:103], v13, s[48:51], s7 offen offset:1024 sc1
    buffer_load_dwordx4 v[104:107], v13, s[48:51], s7 offen offset:2048 sc1
    buffer_load_dwordx4 v[108:111], v13, s[48:51], s7 offen offset:3072 sc1
    s_branch L_ecode_kernel_vloop2
L_ecode_kernel_svc4:
    s_mov_b32 s98, 23
    s_mov_b32 s71, 0
    s_mov_b32 s7, 2475008
    s_waitcnt vmcnt(6)
L_ecode_kernel_rchk:
    v_min3_u32 v7, v96, v97, v98
    v_max3_u32 v8, v96, v97, v98
    v_min3_u32 v7, v7, v99, v100
    v_max3_u32 v8, v8, v99, v100
    v_min3_u32 v7, v7, v101, v102
    v_max3_u32 v8, v8, v101, v102
    v_min3_u32 v7, v7, v103, v104
    v_max3_u32 v8, v8, v103, v104
    v_min3_u32 v7, v7, v105, v106
    v_max3_u32 v8, v8, v105, v106
    v_min3_u32 v7, v7, v107, v108
    v_max3_u32 v8, v8, v107, v108
    v_min3_u32 v7, v7, v109, v110
    v_max3_u32 v8, v8, v109, v110
    v_min_u32 v7, v7, v111
    v_max_u32 v8, v8, v111
    v_xor_b32 v7, s97, v7
    v_xor_b32 v8, s97, v8
    v_or_b32 v7, v7, v8
    v_cmp_ne_u32 vcc, 0, v7
    s_nop 4
    s_cbranch_vccz L_ecode_kernel_rok
    s_add_u32 s71, s71, 1
    s_cmp_ge_u32 s71, 524288
    s_cbranch_scc1 L_ecode_kernel_rok
    s_sleep 16
    buffer_load_dwordx4 v[96:99], v13, s[48:51], s7 offen offset:0 sc1
    buffer_load_dwordx4 v[100:103], v13, s[48:51], s7 offen offset:1024 sc1
    buffer_load_dwordx4 v[104:107], v13, s[48:51], s7 offen offset:2048 sc1
    buffer_load_dwordx4 v[108:111], v13, s[48:51], s7 offen offset:3072 sc1
    s_waitcnt vmcnt(0)
    s_branch L_ecode_kernel_rchk
L_ecode_kernel_rok:
    s_mov_b32 s66, 4
    v_lshrrev_b32 v7, 4, v0
    v_lshlrev_b32 v11, 4, v7
    s_mul_i32 s71, s69, 56
    s_mul_i32 s72, s70, 7168
    s_add_u32 s71, s71, s72
    s_add_u32 s71, s71, 2359296
    buffer_load_dwordx4 v[96:99], v11, s[48:51], s71 offen sc1
    s_add_u32 s71, s71, 14336
    buffer_load_dwordx4 v[100:103], v11, s[48:51], s71 offen sc1
    s_add_u32 s71, s71, 14336
    buffer_load_dwordx4 v[104:107], v11, s[48:51], s71 offen sc1
    s_add_u32 s71, s71, 14336
    buffer_load_dwordx4 v[108:111], v11, s[48:51], s71 offen sc1
    s_add_u32 s71, s71, 14336
    buffer_load_dwordx4 v[112:115], v11, s[48:51], s71 offen sc1
    s_add_u32 s71, s71, 14336
    buffer_load_dwordx4 v[116:119], v11, s[48:51], s71 offen sc1
    s_add_u32 s71, s71, 14336
    buffer_load_dwordx4 v[120:123], v11, s[48:51], s71 offen sc1
    s_add_u32 s71, s71, 14336
    buffer_load_dwordx4 v[124:127], v11, s[48:51], s71 offen sc1
    s_or_b32 s7, s2, s3
    s_cmp_lg_u32 s7, 0
    s_cbranch_scc1 L_ecode_kernel_vloop2
    v_mov_b32 v7, s97
    s_mov_b32 s7, 2479104
    s_mov_b64 exec, 1
    buffer_store_dword v7, off, s[48:51], s7 sc1
    s_mov_b64 exec, -1
    s_branch L_ecode_kernel_vloop2
L_ecode_kernel_switch:
    s_mov_b32 s98, -1
    s_waitcnt vmcnt(6)
    v_mov_b32 v8, v6
    s_nop 1
    v_permlane16_swap_b32 v8, v6
    v_add_f32 v6, v6, v8
    v_mov_b32 v8, v6
    s_nop 1
    v_permlane32_swap_b32 v8, v6
    v_add_f32 v6, v6, v8
    v_lshrrev_b32 v7, 5, v0
    v_lshlrev_b32 v7, 10, v7
    v_and_b32 v12, 15, v0
    v_lshl_add_u32 v7, v12, 5, v7
    v_bfe_u32 v8, v0, 4, 1
    v_lshl_add_u32 v7, v8, 4, v7
    s_lshl_b32 s7, s3, 11
    v_add_u32 v66, s7, v7
    v_bfe_u32 v7, v0, 3, 1
    v_lshlrev_b32 v7, 5, v7
    s_lshl_b32 s7, s3, 2
    v_add_u32 v67, s7, v7
    ds_write_b128 v66, v[28:31] offset:0
    ds_write_b128 v66, v[32:35] offset:512
    ds_write_b32 v67, v5 offset:16384
    ds_write_b32 v67, v6 offset:16400
    v_lshrrev_b32 v7, 3, v0
    v_lshlrev_b32 v71, 13, v7
    v_and_b32 v7, 7, v0
    v_lshl_add_u32 v70, v7, 4, v71
    v_lshrrev_b32 v11, 4, v0
    v_lshlrev_b32 v7, 7, v12
    v_lshl_add_u32 v72, v11, 5, v7
    v_lshlrev_b32 v7, 3, v12
    v_add_u32 v73, 4096, v7
    v_lshl_add_u32 v9, v12, 1, v8
    s_lshl_b32 s7, s3, 5
    s_lshl_b32 s12, s70, 7
    s_add_u32 s7, s7, s12
    s_lshr_b32 s12, s69, 7
    s_add_u32 s7, s7, s12
    v_and_b32 v7, 0, v9
    v_sub_u32 v9, v9, v7
    v_add_u32 v9, s7, v9
    v_lshlrev_b32 v9, 13, v9
    v_lshl_add_u32 v74, v7, 4, v9
    v_cmp_gt_u32 s[72:73], 32, v0
    v_cmp_gt_u32 vcc, 8, v12
    s_and_b64 s[54:55], s[72:73], vcc
    v_cmp_gt_u32 s[56:57], 1, v12
    s_and_b32 s52, s69, 127
    s_lshl_b32 s52, s52, 4
    s_add_u32 s52, s52, 4608
    s_add_u32 s53, s52, 262144
    v_lshlrev_b32 v68, 4, v0
    v_add_u32 v75, 4608, v68
    v_lshlrev_b32 v76, 5, v11
    v_mov_b32 v77, v91
    v_lshlrev_b32 v78, 16, v90
    v_mov_b32 v7, 0
    v_mov_b32 v8, 1
    s_waitcnt lgkmcnt(0)
    s_mov_b64 exec, 1
    ds_add_rtn_u32 v9, v7, v8 offset:33792
    s_mov_b64 exec, -1
    v_mov_b32 v28, 0
    v_mov_b32 v29, 0
    v_mov_b32 v30, 0
    v_mov_b32 v31, 0
    v_mov_b32 v32, 0
    v_mov_b32 v33, 0
    v_mov_b32 v34, 0
    v_mov_b32 v35, 0
    v_mov_b32 v5, 0xff7fffff
    v_mov_b32 v6, 0
    s_nop 0
    v_mov_b32 v14, v15
    s_and_b32 s7, s3, 1
    s_lshl_b32 s7, s7, 3
    s_lshl_b32 s58, s5, 4
    s_add_u32 s58, s58, s7
    s_lshl_b32 s58, s58, 13
    s_add_u32 s7, s4, 16
    s_lshl_b32 s12, s7, 7
    s_add_u32 s12, s12, s58
    s_lshl_b32 s13, s7, 3
    s_add_u32 s13, s13, s58
    s_add_u32 s13, s13, 4096
    s_waitcnt lgkmcnt(0)
    v_readfirstlane_b32 s7, v9
    s_cmp_lg_u32 s7, 3
    s_nop 3
    s_cbranch_scc1 L_ecode_kernel_nopub
    s_lshl_b32 s58, s4, 17
    s_lshl_b32 s7, s5, 7
    s_add_u32 s7, s7, s58
    s_lshl_b32 s59, s5, 3
    s_add_u32 s59, s59, s58
    s_add_u32 s59, s59, 4096
    ds_read_b128 v[52:55], v7 offset:16384
    ds_read_b128 v[56:59], v7 offset:16400
    ds_read_b128 v[36:39], v68 offset:0
    ds_read_b128 v[40:43], v68 offset:2048
    ds_read_b128 v[44:47], v68 offset:4096
    ds_read_b128 v[48:51], v68 offset:6144
    s_waitcnt lgkmcnt(4)
    v_max3_f32 v88, v52, v53, v54
    v_max_f32 v88, v88, v55
    v_sub_f32 v52, v52, v88
    v_sub_f32 v53, v53, v88
    v_sub_f32 v54, v54, v88
    v_sub_f32 v55, v55, v88
    v_mul_f32 v52, s10, v52
    v_mul_f32 v53, s10, v53
    v_mul_f32 v54, s10, v54
    v_mul_f32 v55, s10, v55
    v_exp_f32 v52, v52
    v_exp_f32 v53, v53
    v_exp_f32 v54, v54
    v_exp_f32 v55, v55
    v_mul_f32 v89, v52, v56
    v_fmac_f32 v89, v53, v57
    v_fmac_f32 v89, v54, v58
    v_fmac_f32 v89, v55, v59
    s_waitcnt lgkmcnt(0)
    v_mul_f32 v84, v52, v36
    v_mul_f32 v85, v52, v37
    v_mul_f32 v86, v52, v38
    v_mul_f32 v87, v52, v39
    v_fmac_f32 v84, v53, v40
    v_fmac_f32 v85, v53, v41
    v_fmac_f32 v86, v53, v42
    v_fmac_f32 v87, v53, v43
    v_fmac_f32 v84, v54, v44
    v_fmac_f32 v85, v54, v45
    v_fmac_f32 v86, v54, v46
    v_fmac_f32 v87, v54, v47
    v_fmac_f32 v84, v55, v48
    v_fmac_f32 v85, v55, v49
    v_fmac_f32 v86, v55, v50
    v_fmac_f32 v87, v55, v51
    v_min_u32 v84, -2, v84
    v_min_u32 v85, -2, v85
    v_min_u32 v86, -2, v86
    v_min_u32 v87, -2, v87
    v_min_u32 v88, -2, v88
    v_min_u32 v89, -2, v89
    buffer_store_dwordx4 v[84:87], v70, s[48:51], s7 offen sc1
    s_mov_b64 exec, s[44:45]
    buffer_store_dwordx2 v[88:89], v71, s[48:51], s59 offen sc1
    s_mov_b64 exec, -1
    s_add_u32 s7, s7, 65536
    s_add_u32 s59, s59, 65536
    ds_read_b128 v[52:55], v7 offset:16416
    ds_read_b128 v[56:59], v7 offset:16432
    ds_read_b128 v[36:39], v68 offset:1024
    ds_read_b128 v[40:43], v68 offset:3072
    ds_read_b128 v[44:47], v68 offset:5120
    ds_read_b128 v[48:51], v68 offset:7168
    s_waitcnt lgkmcnt(4)
    v_max3_f32 v12, v52, v53, v54
    v_max_f32 v12, v12, v55
    v_sub_f32 v52, v52, v12
    v_sub_f32 v53, v53, v12
    v_sub_f32 v54, v54, v12
    v_sub_f32 v55, v55, v12
    v_mul_f32 v52, s10, v52
    v_mul_f32 v53, s10, v53
    v_mul_f32 v54, s10, v54
    v_mul_f32 v55, s10, v55
    v_exp_f32 v52, v52
    v_exp_f32 v53, v53
    v_exp_f32 v54, v54
    v_exp_f32 v55, v55
    v_mul_f32 v13, v52, v56
    v_fmac_f32 v13, v53, v57
    v_fmac_f32 v13, v54, v58
    v_fmac_f32 v13, v55, v59
    s_waitcnt lgkmcnt(0)
    v_mul_f32 v8, v52, v36
    v_mul_f32 v9, v52, v37
    v_mul_f32 v10, v52, v38
    v_mul_f32 v11, v52, v39
    v_fmac_f32 v8, v53, v40
    v_fmac_f32 v9, v53, v41
    v_fmac_f32 v10, v53, v42
    v_fmac_f32 v11, v53, v43
    v_fmac_f32 v8, v54, v44
    v_fmac_f32 v9, v54, v45
    v_fmac_f32 v10, v54, v46
    v_fmac_f32 v11, v54, v47
    v_fmac_f32 v8, v55, v48
    v_fmac_f32 v9, v55, v49
    v_fmac_f32 v10, v55, v50
    v_fmac_f32 v11, v55, v51
    v_min_u32 v8, -2, v8
    v_min_u32 v9, -2, v9
    v_min_u32 v10, -2, v10
    v_min_u32 v11, -2, v11
    v_min_u32 v12, -2, v12
    v_min_u32 v13, -2, v13
    buffer_store_dwordx4 v[8:11], v70, s[48:51], s7 offen sc1
    s_mov_b64 exec, s[44:45]
    buffer_store_dwordx2 v[12:13], v71, s[48:51], s59 offen sc1
    s_mov_b64 exec, -1
L_ecode_kernel_nopub:
    s_and_b32 s7, s3, 1
    s_lshl_b32 s58, s7, 10
    v_add_u32 v68, s58, v68
    s_lshl_b32 s7, s7, 5
    v_mov_b32 v69, s7
    v_add_f32 v96, v96, v104
    v_add_f32 v112, v112, v120
    v_add_f32 v96, v96, v112
    v_add_f32 v97, v97, v105
    v_add_f32 v113, v113, v121
    v_add_f32 v97, v97, v113
    v_add_f32 v98, v98, v106
    v_add_f32 v114, v114, v122
    v_add_f32 v98, v98, v114
    v_add_f32 v99, v99, v107
    v_add_f32 v115, v115, v123
    v_add_f32 v99, v99, v115
    v_add_f32 v100, v100, v108
    v_add_f32 v116, v116, v124
    v_add_f32 v100, v100, v116
    v_add_f32 v101, v101, v109
    v_add_f32 v117, v117, v125
    v_add_f32 v101, v101, v117
    v_add_f32 v102, v102, v110
    v_add_f32 v118, v118, v126
    v_add_f32 v102, v102, v118
    v_add_f32 v103, v103, v111
    v_add_f32 v119, v119, v127
    v_add_f32 v103, v103, v119
    v_cvt_pk_bf16_f32 v7, v96, v100
    v_and_b32 v8, 0xffff0000, v7
    v_lshlrev_b32 v7, 16, v7
    v_mul_f32 v9, 0xbfb8aa3b, v7
    v_exp_f32 v9, v9
    s_nop 0
    v_add_f32 v9, 1.0, v9
    v_rcp_f32 v9, v9
    s_nop 0
    v_mul_f32 v9, v9, v7
    v_cvt_pk_bf16_f32 v9, v9, v9
    v_lshlrev_b32 v9, 16, v9
    v_mul_f32 v9, v9, v8
    v_cvt_pk_bf16_f32 v84, v9, v9
    v_cvt_pk_bf16_f32 v7, v97, v101
    v_and_b32 v8, 0xffff0000, v7
    v_lshlrev_b32 v7, 16, v7
    v_mul_f32 v9, 0xbfb8aa3b, v7
    v_exp_f32 v9, v9
    s_nop 0
    v_add_f32 v9, 1.0, v9
    v_rcp_f32 v9, v9
    s_nop 0
    v_mul_f32 v9, v9, v7
    v_cvt_pk_bf16_f32 v9, v9, v9
    v_lshlrev_b32 v9, 16, v9
    v_mul_f32 v9, v9, v8
    v_cvt_pk_bf16_f32 v85, v9, v9
    v_cvt_pk_bf16_f32 v7, v98, v102
    v_and_b32 v8, 0xffff0000, v7
    v_lshlrev_b32 v7, 16, v7
    v_mul_f32 v9, 0xbfb8aa3b, v7
    v_exp_f32 v9, v9
    s_nop 0
    v_add_f32 v9, 1.0, v9
    v_rcp_f32 v9, v9
    s_nop 0
    v_mul_f32 v9, v9, v7
    v_cvt_pk_bf16_f32 v9, v9, v9
    v_lshlrev_b32 v9, 16, v9
    v_mul_f32 v9, v9, v8
    v_cvt_pk_bf16_f32 v86, v9, v9
    v_cvt_pk_bf16_f32 v7, v99, v103
    v_and_b32 v8, 0xffff0000, v7
    v_lshlrev_b32 v7, 16, v7
    v_mul_f32 v9, 0xbfb8aa3b, v7
    v_exp_f32 v9, v9
    s_nop 0
    v_add_f32 v9, 1.0, v9
    v_rcp_f32 v9, v9
    s_nop 0
    v_mul_f32 v9, v9, v7
    v_cvt_pk_bf16_f32 v9, v9, v9
    v_lshlrev_b32 v9, 16, v9
    v_mul_f32 v9, v9, v8
    v_cvt_pk_bf16_f32 v87, v9, v9
    v_cmp_gt_u32 vcc, 48, v0
    s_nop 1
    v_cndmask_b32 v86, 0, v86, vcc
    v_cndmask_b32 v87, 0, v87, vcc
    s_cmp_lg_u32 s11, s76
    s_nop 0
    s_cbranch_scc1 L_ecode_kernel_vloop2
L_ecode_kernel_sdone:
    s_cmp_lg_u32 s98, -1
    s_cbranch_scc1 L_ecode_kernel_switch
    v_mov_b32 v8, v6
    s_nop 1
    v_permlane16_swap_b32 v8, v6
    v_add_f32 v6, v6, v8
    v_mov_b32 v8, v6
    s_nop 1
    v_permlane32_swap_b32 v8, v6
    v_add_f32 v6, v6, v8
    ds_write_b128 v66, v[28:31] offset:8192
    ds_write_b128 v66, v[32:35] offset:8704
    ds_write_b32 v67, v5 offset:16448
    ds_write_b32 v67, v6 offset:16464
    s_mov_b32 s71, 0
    s_waitcnt lgkmcnt(0)
    s_barrier
    s_cmp_eq_u32 s3, 3
    s_cbranch_scc1 L_ecode_kernel_p1s
    s_cmp_eq_u32 s3, 2
    s_cbranch_scc1 L_ecode_kernel_p1y
    ds_read_b128 v[96:99], v69 offset:16448
    ds_read_b128 v[100:103], v69 offset:16464
    ds_read_b128 v[36:39], v68 offset:8192
    ds_read_b128 v[40:43], v68 offset:10240
    ds_read_b128 v[44:47], v68 offset:12288
    ds_read_b128 v[48:51], v68 offset:14336
    s_waitcnt lgkmcnt(4)
    v_max3_f32 v108, v96, v97, v98
    v_max_f32 v108, v108, v99
    v_sub_f32 v96, v96, v108
    v_sub_f32 v97, v97, v108
    v_sub_f32 v98, v98, v108
    v_sub_f32 v99, v99, v108
    v_mul_f32 v96, s10, v96
    v_mul_f32 v97, s10, v97
    v_mul_f32 v98, s10, v98
    v_mul_f32 v99, s10, v99
    v_exp_f32 v96, v96
    v_exp_f32 v97, v97
    v_exp_f32 v98, v98
    v_exp_f32 v99, v99
    v_mul_f32 v109, v96, v100
    v_fmac_f32 v109, v97, v101
    v_fmac_f32 v109, v98, v102
    v_fmac_f32 v109, v99, v103
    s_waitcnt lgkmcnt(0)
    v_mul_f32 v104, v96, v36
    v_mul_f32 v105, v96, v37
    v_mul_f32 v106, v96, v38
    v_mul_f32 v107, v96, v39
    v_fmac_f32 v104, v97, v40
    v_fmac_f32 v105, v97, v41
    v_fmac_f32 v106, v97, v42
    v_fmac_f32 v107, v97, v43
    v_fmac_f32 v104, v98, v44
    v_fmac_f32 v105, v98, v45
    v_fmac_f32 v106, v98, v46
    v_fmac_f32 v107, v98, v47
    v_fmac_f32 v104, v99, v48
    v_fmac_f32 v105, v99, v49
    v_fmac_f32 v106, v99, v50
    v_fmac_f32 v107, v99, v51
    v_min_u32 v104, -2, v104
    v_min_u32 v105, -2, v105
    v_min_u32 v106, -2, v106
    v_min_u32 v107, -2, v107
    v_min_u32 v108, -2, v108
    v_min_u32 v109, -2, v109
    buffer_store_dwordx4 v[104:107], v70, s[48:51], s12 offen sc1
    s_mov_b64 exec, s[44:45]
    buffer_store_dwordx2 v[108:109], v71, s[48:51], s13 offen sc1
    s_mov_b64 exec, -1
L_ecode_kernel_p1x:
    s_branch L_ecode_kernel_p1w
L_ecode_kernel_p1s:
L_ecode_kernel_p1a:
    buffer_load_dwordx4 v[36:39], v72, s[48:51], s68 offen offset:0 sc1
    buffer_load_dwordx4 v[40:43], v72, s[48:51], s68 offen offset:16 sc1
    buffer_load_dwordx2 v[96:97], v73, s[48:51], s68 offen offset:0 sc1
    buffer_load_dwordx4 v[44:47], v72, s[48:51], s68 offen offset:2048 sc1
    buffer_load_dwordx4 v[48:51], v72, s[48:51], s68 offen offset:2064 sc1
    buffer_load_dwordx2 v[98:99], v73, s[48:51], s68 offen offset:128 sc1
    s_waitcnt vmcnt(0)
    v_max3_u32 v12, v36, v37, v38
    v_max3_u32 v13, v39, v40, v41
    v_max3_u32 v12, v12, v42, v43
    v_max3_u32 v13, v13, v96, v97
    v_max_u32 v12, v12, v13
    v_cmp_eq_u32 vcc, -1, v12
    s_add_u32 s71, s71, 1
    s_cmp_ge_u32 s71, 524288
    s_nop 2
    s_cbranch_scc1 L_ecode_kernel_p1d
    s_cbranch_vccnz L_ecode_kernel_p1a
    s_branch L_ecode_kernel_p1c
L_ecode_kernel_p1b:
    buffer_load_dwordx4 v[44:47], v72, s[48:51], s68 offen offset:2048 sc1
    buffer_load_dwordx4 v[48:51], v72, s[48:51], s68 offen offset:2064 sc1
    buffer_load_dwordx2 v[98:99], v73, s[48:51], s68 offen offset:128 sc1
    s_waitcnt vmcnt(0)
L_ecode_kernel_p1c:
    v_max3_u32 v12, v44, v45, v46
    v_max3_u32 v13, v47, v48, v49
    v_max3_u32 v12, v12, v50, v51
    v_max3_u32 v13, v13, v98, v99
    v_max_u32 v12, v12, v13
    v_cmp_eq_u32 vcc, -1, v12
    s_add_u32 s71, s71, 1
    s_cmp_ge_u32 s71, 524288
    s_nop 2
    s_cbranch_scc1 L_ecode_kernel_p1d
    s_cbranch_vccz L_ecode_kernel_p1d
    s_mov_b64 exec, vcc
    s_branch L_ecode_kernel_p1b
L_ecode_kernel_p1d:
    s_mov_b64 exec, -1
    v_max_f32 v12, v96, v98
    s_nop 1
    v_max_f32_dpp v12, v12, v12 quad_perm:[1,0,3,2] row_mask:0xf bank_mask:0xf
    s_nop 1
    v_max_f32_dpp v12, v12, v12 quad_perm:[2,3,0,1] row_mask:0xf bank_mask:0xf
    s_nop 1
    v_max_f32_dpp v12, v12, v12 row_half_mirror row_mask:0xf bank_mask:0xf
    s_nop 1
    v_max_f32_dpp v12, v12, v12 row_mirror row_mask:0xf bank_mask:0xf
    v_sub_f32 v10, v96, v12
    v_sub_f32 v11, v98, v12
    v_mul_f32 v10, s10, v10
    v_mul_f32 v11, s10, v11
    v_exp_f32 v10, v10
    v_exp_f32 v11, v11
    v_mul_f32 v13, v10, v97
    v_fmac_f32 v13, v11, v99
    v_mul_f32 v104, v36, v10
    v_mul_f32 v105, v37, v10
    v_mul_f32 v106, v38, v10
    v_mul_f32 v107, v39, v10
    v_mul_f32 v108, v40, v10
    v_mul_f32 v109, v41, v10
    v_mul_f32 v110, v42, v10
    v_mul_f32 v111, v43, v10
    v_fmac_f32 v104, v44, v11
    v_fmac_f32 v105, v45, v11
    v_fmac_f32 v106, v46, v11
    v_fmac_f32 v107, v47, v11
    v_fmac_f32 v108, v48, v11
    v_fmac_f32 v109, v49, v11
    v_fmac_f32 v110, v50, v11
    v_fmac_f32 v111, v51, v11
    v_add_f32_dpp v13, v13, v13 quad_perm:[1,0,3,2] row_mask:0xf bank_mask:0xf
    v_add_f32_dpp v104, v104, v104 quad_perm:[1,0,3,2] row_mask:0xf bank_mask:0xf
    v_add_f32_dpp v105, v105, v105 quad_perm:[1,0,3,2] row_mask:0xf bank_mask:0xf
    v_add_f32_dpp v106, v106, v106 quad_perm:[1,0,3,2] row_mask:0xf bank_mask:0xf
    v_add_f32_dpp v107, v107, v107 quad_perm:[1,0,3,2] row_mask:0xf bank_mask:0xf
    v_add_f32_dpp v108, v108, v108 quad_perm:[1,0,3,2] row_mask:0xf bank_mask:0xf
    v_add_f32_dpp v109, v109, v109 quad_perm:[1,0,3,2] row_mask:0xf bank_mask:0xf
    v_add_f32_dpp v110, v110, v110 quad_perm:[1,0,3,2] row_mask:0xf bank_mask:0xf
    v_add_f32_dpp v111, v111, v111 quad_perm:[1,0,3,2] row_mask:0xf bank_mask:0xf
    v_add_f32_dpp v13, v13, v13 quad_perm:[2,3,0,1] row_mask:0xf bank_mask:0xf
    v_add_f32_dpp v104, v104, v104 quad_perm:[2,3,0,1] row_mask:0xf bank_mask:0xf
    v_add_f32_dpp v105, v105, v105 quad_perm:[2,3,0,1] row_mask:0xf bank_mask:0xf
    v_add_f32_dpp v106, v106, v106 quad_perm:[2,3,0,1] row_mask:0xf bank_mask:0xf
    v_add_f32_dpp v107, v107, v107 quad_perm:[2,3,0,1] row_mask:0xf bank_mask:0xf
    v_add_f32_dpp v108, v108, v108 quad_perm:[2,3,0,1] row_mask:0xf bank_mask:0xf
    v_add_f32_dpp v109, v109, v109 quad_perm:[2,3,0,1] row_mask:0xf bank_mask:0xf
    v_add_f32_dpp v110, v110, v110 quad_perm:[2,3,0,1] row_mask:0xf bank_mask:0xf
    v_add_f32_dpp v111, v111, v111 quad_perm:[2,3,0,1] row_mask:0xf bank_mask:0xf
    v_add_f32_dpp v13, v13, v13 row_half_mirror row_mask:0xf bank_mask:0xf
    v_add_f32_dpp v104, v104, v104 row_half_mirror row_mask:0xf bank_mask:0xf
    v_add_f32_dpp v105, v105, v105 row_half_mirror row_mask:0xf bank_mask:0xf
    v_add_f32_dpp v106, v106, v106 row_half_mirror row_mask:0xf bank_mask:0xf
    v_add_f32_dpp v107, v107, v107 row_half_mirror row_mask:0xf bank_mask:0xf
    v_add_f32_dpp v108, v108, v108 row_half_mirror row_mask:0xf bank_mask:0xf
    v_add_f32_dpp v109, v109, v109 row_half_mirror row_mask:0xf bank_mask:0xf
    v_add_f32_dpp v110, v110, v110 row_half_mirror row_mask:0xf bank_mask:0xf
    v_add_f32_dpp v111, v111, v111 row_half_mirror row_mask:0xf bank_mask:0xf
    v_add_f32_dpp v13, v13, v13 row_mirror row_mask:0xf bank_mask:0xf
    v_add_f32_dpp v104, v104, v104 row_mirror row_mask:0xf bank_mask:0xf
    v_add_f32_dpp v105, v105, v105 row_mirror row_mask:0xf bank_mask:0xf
    v_add_f32_dpp v106, v106, v106 row_mirror row_mask:0xf bank_mask:0xf
    v_add_f32_dpp v107, v107, v107 row_mirror row_mask:0xf bank_mask:0xf
    v_add_f32_dpp v108, v108, v108 row_mirror row_mask:0xf bank_mask:0xf
    v_add_f32_dpp v109, v109, v109 row_mirror row_mask:0xf bank_mask:0xf
    v_add_f32_dpp v110, v110, v110 row_mirror row_mask:0xf bank_mask:0xf
    v_add_f32_dpp v111, v111, v111 row_mirror row_mask:0xf bank_mask:0xf
    v_rcp_f32 v13, v13
    s_nop 0
    v_mul_f32 v104, v104, v13
    v_mul_f32 v105, v105, v13
    v_mul_f32 v106, v106, v13
    v_mul_f32 v107, v107, v13
    v_mul_f32 v108, v108, v13
    v_mul_f32 v109, v109, v13
    v_mul_f32 v110, v110, v13
    v_mul_f32 v111, v111, v13
    v_cvt_pk_bf16_f32 v104, v104, v104
    v_cvt_pk_bf16_f32 v105, v105, v105
    v_cvt_pk_bf16_f32 v106, v106, v106
    v_cvt_pk_bf16_f32 v107, v107, v107
    v_cvt_pk_bf16_f32 v108, v108, v108
    v_cvt_pk_bf16_f32 v109, v109, v109
    v_cvt_pk_bf16_f32 v110, v110, v110
    v_cvt_pk_bf16_f32 v111, v111, v111
    ds_write_b128 v76, v[104:107] offset:24320
    ds_write_b128 v76, v[108:111] offset:24336
    s_mov_b32 s71, 0
    s_waitcnt lgkmcnt(0)
    s_barrier
    s_cmp_ge_u32 s69, 112
    s_cbranch_scc1 L_ecode_kernel_end
    s_and_b32 s7, s69, 0
    s_cbranch_scc1 L_ecode_kernel_end
    s_add_u32 s12, s68, 8192
    s_add_u32 s13, s68, 16384
    s_add_u32 s14, s68, 24576
    s_barrier
L_ecode_kernel_p2:
    buffer_load_dwordx4 v[128:131], v75, s[48:51], s68 offen offset:0 sc1
    buffer_load_dwordx4 v[132:135], v75, s[48:51], s68 offen offset:1024 sc1
    s_waitcnt vmcnt(0)
    v_max_u32 v12, v128, v129
    v_max3_u32 v12, v12, v130, v131
    v_max3_u32 v12, v12, v132, v133
    v_max3_u32 v12, v12, v134, v135
    v_cmp_eq_u32 vcc, -1, v12
    s_add_u32 s71, s71, 1
    s_cmp_ge_u32 s71, 524288
    s_nop 2
    s_cbranch_scc1 L_ecode_kernel_p2d
    s_cbranch_vccz L_ecode_kernel_p2d
    s_mov_b64 exec, vcc
    s_branch L_ecode_kernel_p2
L_ecode_kernel_p2d:
    s_mov_b64 exec, -1
    v_add_f32 v112, v128, v132
    v_add_f32 v113, v129, v133
    v_add_f32 v114, v130, v134
    v_add_f32 v115, v131, v135
    v_permlane16_swap_b32 v112, v113
    s_nop 0
    v_permlane16_swap_b32 v114, v115
    v_add_f32 v112, v112, v113
    v_add_f32 v114, v114, v115
    s_nop 1
    v_permlane32_swap_b32 v112, v114
    v_add_f32 v112, v112, v114
    s_nop 1
    v_add_f32_dpp v112, v112, v112 quad_perm:[1,0,3,2] row_mask:0xf bank_mask:0xf
    s_nop 1
    v_add_f32_dpp v112, v112, v112 quad_perm:[2,3,0,1] row_mask:0xf bank_mask:0xf
    s_nop 1
    v_add_f32_dpp v112, v112, v112 row_ror:4 row_mask:0xf bank_mask:0xf
    s_nop 1
    v_add_f32_dpp v112, v112, v112 row_ror:8 row_mask:0xf bank_mask:0xf
    v_add_f32 v112, v112, v78
    v_cvt_pk_bf16_f32 v112, v112, v112
    s_mov_b64 exec, s[56:57]
    buffer_store_short v112, v77, s[60:63], s74 offen
    s_branch L_ecode_kernel_end
L_ecode_kernel_p1y:
    s_waitcnt vmcnt(0)
L_ecode_kernel_p1w:
    s_waitcnt vmcnt(2)
    v_and_b32 v52, v84, v16
    v_and_b32 v53, v84, v17
    v_and_b32 v54, v84, v18
    v_and_b32 v55, v84, v19
    s_nop 1
    v_mfma_f32_16x16x32_bf16 v[92:95], v[52:55], a[192:195], 0
    v_mfma_f32_16x16x32_bf16 v[80:83], v[52:55], a[208:211], 0
    v_and_b32 v56, v85, v16
    v_and_b32 v57, v85, v17
    v_and_b32 v58, v85, v18
    v_and_b32 v59, v85, v19
    s_nop 1
    v_mfma_f32_16x16x32_bf16 v[92:95], v[56:59], a[196:199], v[92:95]
    v_mfma_f32_16x16x32_bf16 v[80:83], v[56:59], a[212:215], v[80:83]
    v_and_b32 v52, v86, v16
    v_and_b32 v53, v86, v17
    v_and_b32 v54, v86, v18
    v_and_b32 v55, v86, v19
    s_nop 1
    v_mfma_f32_16x16x32_bf16 v[92:95], v[52:55], a[200:203], v[92:95]
    v_mfma_f32_16x16x32_bf16 v[80:83], v[52:55], a[216:219], v[80:83]
    v_and_b32 v56, v87, v16
    v_and_b32 v57, v87, v17
    v_and_b32 v58, v87, v18
    v_and_b32 v59, v87, v19
    s_nop 1
    v_mfma_f32_16x16x32_bf16 v[92:95], v[56:59], a[204:207], v[92:95]
    v_mfma_f32_16x16x32_bf16 v[80:83], v[56:59], a[220:223], v[80:83]
    s_nop 7
    s_barrier
    ds_read_b128 v[112:115], v76 offset:24320
    ds_read_b128 v[116:119], v76 offset:24336
    s_waitcnt lgkmcnt(0)
    v_and_b32 v52, v112, v16
    v_and_b32 v53, v112, v17
    v_and_b32 v54, v112, v18
    v_and_b32 v55, v112, v19
    s_nop 1
    v_mfma_f32_16x16x32_bf16 v[92:95], v[52:55], a[128:131], v[92:95]
    v_mfma_f32_16x16x32_bf16 v[80:83], v[52:55], a[160:163], v[80:83]
    v_and_b32 v56, v113, v16
    v_and_b32 v57, v113, v17
    v_and_b32 v58, v113, v18
    v_and_b32 v59, v113, v19
    s_nop 1
    v_mfma_f32_16x16x32_bf16 v[92:95], v[56:59], a[132:135], v[92:95]
    v_mfma_f32_16x16x32_bf16 v[80:83], v[56:59], a[164:167], v[80:83]
    v_and_b32 v52, v114, v16
    v_and_b32 v53, v114, v17
    v_and_b32 v54, v114, v18
    v_and_b32 v55, v114, v19
    s_nop 1
    v_mfma_f32_16x16x32_bf16 v[92:95], v[52:55], a[136:139], v[92:95]
    v_mfma_f32_16x16x32_bf16 v[80:83], v[52:55], a[168:171], v[80:83]
    v_and_b32 v56, v115, v16
    v_and_b32 v57, v115, v17
    v_and_b32 v58, v115, v18
    v_and_b32 v59, v115, v19
    s_nop 1
    v_mfma_f32_16x16x32_bf16 v[92:95], v[56:59], a[140:143], v[92:95]
    v_mfma_f32_16x16x32_bf16 v[80:83], v[56:59], a[172:175], v[80:83]
    v_and_b32 v52, v116, v16
    v_and_b32 v53, v116, v17
    v_and_b32 v54, v116, v18
    v_and_b32 v55, v116, v19
    s_nop 1
    v_mfma_f32_16x16x32_bf16 v[92:95], v[52:55], a[144:147], v[92:95]
    v_mfma_f32_16x16x32_bf16 v[80:83], v[52:55], a[176:179], v[80:83]
    v_and_b32 v56, v117, v16
    v_and_b32 v57, v117, v17
    v_and_b32 v58, v117, v18
    v_and_b32 v59, v117, v19
    s_nop 1
    v_mfma_f32_16x16x32_bf16 v[92:95], v[56:59], a[148:151], v[92:95]
    v_mfma_f32_16x16x32_bf16 v[80:83], v[56:59], a[180:183], v[80:83]
    v_and_b32 v52, v118, v16
    v_and_b32 v53, v118, v17
    v_and_b32 v54, v118, v18
    v_and_b32 v55, v118, v19
    s_nop 1
    v_mfma_f32_16x16x32_bf16 v[92:95], v[52:55], a[152:155], v[92:95]
    v_mfma_f32_16x16x32_bf16 v[80:83], v[52:55], a[184:187], v[80:83]
    v_and_b32 v56, v119, v16
    v_and_b32 v57, v119, v17
    v_and_b32 v58, v119, v18
    v_and_b32 v59, v119, v19
    s_nop 1
    v_mfma_f32_16x16x32_bf16 v[92:95], v[56:59], a[156:159], v[92:95]
    v_mfma_f32_16x16x32_bf16 v[80:83], v[56:59], a[188:191], v[80:83]
    s_nop 6
    v_min_u32 v92, -2, v92
    v_min_u32 v93, -2, v93
    v_min_u32 v94, -2, v94
    v_min_u32 v95, -2, v95
    s_mov_b64 exec, s[72:73]
    buffer_store_dwordx4 v[92:95], v74, s[48:51], s52 offen sc1
    s_cmp_lg_u32 s3, 2
    s_nop 0
    s_cbranch_scc1 L_ecode_kernel_pe
    s_mov_b64 exec, s[54:55]
    v_min_u32 v80, -2, v80
    v_min_u32 v81, -2, v81
    v_min_u32 v82, -2, v82
    v_min_u32 v83, -2, v83
    buffer_store_dwordx4 v[80:83], v74, s[48:51], s53 offen sc1
L_ecode_kernel_pe:
    s_waitcnt vmcnt(0)
    s_nop 0
    s_barrier
L_ecode_kernel_end:
L_ecode_kernel_end2:
    s_endpgm
.section .rodata,"a"
.p2align 6
.amdhsa_kernel parallel_sum__gqa_block_cached__glu_gated_swiglu__decode_kernel
  .amdhsa_next_free_vgpr 512
  .amdhsa_next_free_sgpr 102
  .amdhsa_accum_offset 256
  .amdhsa_group_segment_fixed_size 0
  .amdhsa_kernarg_size 96
  .amdhsa_user_sgpr_count 2
  .amdhsa_user_sgpr_kernarg_segment_ptr 1
  .amdhsa_system_sgpr_workgroup_id_x 1
  .amdhsa_float_denorm_mode_32 3
.end_amdhsa_kernel
```
